```python
import torch

def _softmax(x, axis=-1):
    return torch.softmax(x, dim=axis)
def _gelu(x):
    return torch.nn.functional.gelu(x, approximate="tanh")
def _silu(x):
    return torch.nn.functional.silu(x)
def _sigmoid(x):
    return torch.sigmoid(x)
def _layernorm(x, axis=-1, eps=1e-5):
    m = x.mean(dim=axis, keepdim=True)
    v = x.var(dim=axis, keepdim=True, unbiased=False)
    return (x - m) / torch.sqrt(v + eps)
def _scatter_add(tgt, idx, src, axis=0):
    return tgt.clone().index_add_(axis, idx, src)
def _segment_sum(src, seg, n):
    out = torch.zeros((n,) + src.shape[1:], dtype=src.dtype)
    return out.index_add_(0, seg, src)
def _pad(x, pw):
    flat = tuple(v for pair in reversed(pw) for v in pair)
    return torch.nn.functional.pad(x, flat)

kernel_name = 'gated_mix__ssm_conv_s4__dense_activation_squared_relu__prompt'

def setup_inputs():

    _w = (lambda a: (lambda t: t.to(torch.bfloat16) if t.is_floating_point() else t)(torch.as_tensor(a)))
    def _A_setup():
        B, L, D, N = 1, 2048, 512, 128
        A_re = -(lambda _x: torch.exp(torch.as_tensor(_x)))((lambda *s: torch.randn(*s, dtype=torch.bfloat16) * 6.4)(D, N))
        A_im = torch.pi * (lambda *s: torch.randn(*s, dtype=torch.bfloat16) * 0.1)(D, N)
        B_re = (lambda *s: torch.randn(*s, dtype=torch.bfloat16) * 0.2)(D, N)
        B_im = (lambda *s: torch.randn(*s, dtype=torch.bfloat16) * 0.2)(D, N)
        C_re = (lambda *s: torch.randn(*s, dtype=torch.bfloat16) * 0.2)(D, N)
        C_im = (lambda *s: torch.randn(*s, dtype=torch.bfloat16) * 0.2)(D, N)
        log_dt = (lambda *s: torch.randn(*s, dtype=torch.bfloat16) * 0.1)(D) * 0.5 - 4.0
        Dskip = (lambda *s: torch.randn(*s, dtype=torch.bfloat16) * 0.1)(D)
        return {
            "u": _w((lambda *s: torch.randn(*s, dtype=torch.bfloat16) * 0.05)(B, L, D)),
            "A_re": _w(A_re),
            "A_im": _w(A_im),
            "B_re": _w(B_re),
            "B_im": _w(B_im),
            "C_re": _w(C_re),
            "C_im": _w(C_im),
            "log_dt": _w(log_dt),
            "Dskip": _w(Dskip),
        }
    _A_in = _A_setup()

    def _B_setup():
        B, S, D, F = 1, 2048, 512, 1792
        return {
            "x": _w((lambda *s: torch.randn(*s, dtype=torch.bfloat16) * 0.05)(B, S, D)),
            "w1": _w((lambda *s: torch.randn(*s, dtype=torch.bfloat16) * 0.05)(D, F)),
            "b1": _w((lambda *s: torch.randn(*s, dtype=torch.bfloat16) * 0.05)(F)),
            "w2": _w((lambda *s: torch.randn(*s, dtype=torch.bfloat16) * 0.05)(F, D)),
            "b2": _w((lambda *s: torch.randn(*s, dtype=torch.bfloat16) * 0.05)(D)),
        }
    _B_in = _B_setup()

    return {
        "A_u": _A_in["u"],
        "A_A_re": _A_in["A_re"],
        "A_A_im": _A_in["A_im"],
        "A_B_re": _A_in["B_re"],
        "A_B_im": _A_in["B_im"],
        "A_C_re": _A_in["C_re"],
        "A_C_im": _A_in["C_im"],
        "A_log_dt": _A_in["log_dt"],
        "A_Dskip": _A_in["Dskip"],
        "B_x": _B_in["x"],
        "B_w1": _B_in["w1"],
        "B_b1": _B_in["b1"],
        "B_w2": _B_in["w2"],
        "B_b2": _B_in["b2"],
        "gate_w": _w((lambda *s: torch.randn(*s, dtype=torch.bfloat16) * 0.05)(512) * 16.0),
    }

def reference(A_u, A_A_re, A_A_im, A_B_re, A_B_im, A_C_re, A_C_im, A_log_dt, A_Dskip, B_x, B_w1, B_b1, B_w2, B_b2, gate_w):
    def _A_ref(u, A_re, A_im, B_re, B_im, C_re, C_im, log_dt, Dskip):
        Bsz, L, D = u.shape
        dt = torch.exp(log_dt)[:, None]
        A = A_re + 1j * A_im
        Bc = B_re + 1j * B_im
        Cc = C_re + 1j * C_im
        logdA = dt * A
        dB = dt * Bc
        l = (lambda x, dt: x.to(dt))(torch.arange(L), A_re.dtype)
        P = torch.exp(logdA[:, :, None] * l[None, None, :])
        K = torch.einsum("dn,dnl,dn->dl", Cc, P, dB).real
        L2 = 2 * L
        Kp = _pad(K, ((0, 0), (0, L)))
        up = (lambda x, *d: x.permute(*d))(u, 0, 2, 1)
        up = _pad(up, ((0, 0), (0, 0), (0, L)))
        Kf = (lambda x, axes=(-2,-1): torch.fft.rfft2(x.float(), dim=axes))(Kp[:, None, :], axes=(-2, -1))
        Uf = (lambda x, axes=(-2,-1): torch.fft.rfft2(x.float(), dim=axes))(up[:, :, None, :], axes=(-2, -1))
        Yf = Uf * Kf[None, :, :, :]
        y = (lambda x, s, axes=(-2,-1): torch.fft.irfft2(x, s=s, dim=axes).to(torch.bfloat16))(Yf, (1, L2), axes=(-2, -1))[:, :, 0, :L]
        y = (lambda x, *d: x.permute(*d))(y, 0, 2, 1) + u * Dskip[None, None, :]
        return y

    def _B_ref(x, w1, b1, w2, b2):
        h = torch.einsum("bsd,df->bsf", x, w1) + b1
        zero = torch.zeros_like(h)
        r = torch.where(h > zero, h, zero)
        h = r * r
        out = torch.einsum("bsf,fd->bsd", h, w2) + b2
        return out

    x = A_u
    g = _sigmoid((x * gate_w).sum(-1, keepdims=True))
    a = _A_ref(x, A_A_re, A_A_im, A_B_re, A_B_im, A_C_re, A_C_im, A_log_dt, A_Dskip)
    b = _B_ref(x, B_w1, B_b1, B_w2, B_b2)
    return g * a + (1 - g) * b
```

```asm
; @launch grid=(256,1,1) block=(512,1,1) lds=163840
.amdgcn_target "amdgcn-amd-amdhsa--gfx950"
.text
.globl gated_mix__ssm_conv_s4__dense_activation_squared_relu__prompt_kernel
.p2align 8
.type gated_mix__ssm_conv_s4__dense_activation_squared_relu__prompt_kernel,@function
gated_mix__ssm_conv_s4__dense_activation_squared_relu__prompt_kernel:
    s_cmp_ge_u32 s2, 256
    s_cbranch_scc1 k_end_1
    s_load_dwordx16 s[4:19], s[0:1], 0
    s_load_dwordx16 s[20:35], s[0:1], 64
    s_load_dwordx4 s[36:39], s[0:1], 128
    v_and_b32 v1, 63, v0
    v_lshrrev_b32 v2, 6, v0
    s_and_b32 s92, s2, 7
    v_readfirstlane_b32 s84, v2
    s_lshr_b32 s93, s2, 3
    s_lshl_b32 s85, s92, 5
    s_add_u32 s85, s85, s93
    s_lshl_b32 s86, s92, 1
    s_and_b32 s87, s93, 1
    s_add_u32 s86, s86, s87
    s_lshr_b32 s87, s93, 1
    s_lshl_b32 s88, s92, 2
    s_and_b32 s94, s93, 3
    s_add_u32 s88, s88, s94
    s_lshr_b32 s89, s93, 2
    v_and_b32 v10, 15, v1
    v_lshrrev_b32 v11, 4, v1
    s_cmp_ge_u32 s84, 4
    s_cbranch_scc1 roleB_2
    s_setprio 3
    s_lshl_b32 s3, s85, 1
    s_lshr_b32 s92, s84, 1
    s_add_u32 s3, s3, s92
    s_lshl_b32 s92, s3, 8
    s_and_b32 s93, s84, 1
    s_lshl_b32 s93, s93, 7
    s_add_u32 s92, s92, s93
    v_lshlrev_b32 v2, 1, v1
    v_add_u32 v2, s92, v2
    s_lshl_b32 s92, s3, 1
    v_mov_b32 v3, s92
    s_mul_i32 s92, s87, 224
    v_lshlrev_b32 v4, 3, v11
    v_add_u32 v4, s92, v4
    s_lshr_b32 s92, s84, 1
    s_mul_i32 s92, s92, 30096
    s_and_b32 s93, s84, 1
    s_lshl_b32 s93, s93, 8
    s_add_u32 s92, s92, s93
    s_add_u32 s92, s92, 90112
    v_lshlrev_b32 v5, 2, v1
    v_add_u32 v5, s92, v5
    v_mov_b32 v12, 4096
    s_waitcnt lgkmcnt(0)
    s_mov_b32 s76, s6
    s_mov_b32 s77, s7
    s_mov_b32 s78, 131072
    s_mov_b32 s79, 0x20000
    buffer_load_ushort v20, v2, s[76:79], 0 offen
    s_mov_b32 s80, s8
    s_mov_b32 s81, s9
    s_mov_b32 s82, 131072
    s_mov_b32 s83, 0x20000
    buffer_load_ushort v21, v2, s[80:83], 0 offen
    s_mov_b32 s76, s10
    s_mov_b32 s77, s11
    s_mov_b32 s78, 131072
    s_mov_b32 s79, 0x20000
    buffer_load_ushort v22, v2, s[76:79], 0 offen
    s_mov_b32 s80, s12
    s_mov_b32 s81, s13
    s_mov_b32 s82, 131072
    s_mov_b32 s83, 0x20000
    buffer_load_ushort v23, v2, s[80:83], 0 offen
    s_mov_b32 s76, s14
    s_mov_b32 s77, s15
    s_mov_b32 s78, 131072
    s_mov_b32 s79, 0x20000
    buffer_load_ushort v24, v2, s[76:79], 0 offen
    s_mov_b32 s80, s16
    s_mov_b32 s81, s17
    s_mov_b32 s82, 131072
    s_mov_b32 s83, 0x20000
    buffer_load_ushort v25, v2, s[80:83], 0 offen
    s_mov_b32 s76, s18
    s_mov_b32 s77, s19
    s_mov_b32 s78, 1024
    s_mov_b32 s79, 0x20000
    buffer_load_ushort v26, v3, s[76:79], 0 offen
    s_add_u32 s48, s38, 12648448
    s_addc_u32 s49, s39, 0
    s_mov_b32 s50, 8192
    s_mov_b32 s51, 0x20000
    buffer_load_dword v6, v12, s[48:51], 0 offen sc1
    s_mov_b32 s80, s20
    s_mov_b32 s81, s21
    s_mov_b32 s82, 1024
    s_mov_b32 s83, 0x20000
    buffer_load_ushort v250, v3, s[80:83], 0 offen
    s_mov_b32 s76, s26
    s_mov_b32 s77, s27
    s_mov_b32 s78, 3584
    s_mov_b32 s79, 0x20000
    buffer_load_dwordx2 v[232:233], v4, s[76:79], 0 offen offset:0
    buffer_load_dwordx2 v[234:235], v4, s[76:79], 0 offen offset:32
    buffer_load_dwordx2 v[236:237], v4, s[76:79], 0 offen offset:64
    buffer_load_dwordx2 v[238:239], v4, s[76:79], 0 offen offset:96
    buffer_load_dwordx2 v[240:241], v4, s[76:79], 0 offen offset:128
    buffer_load_dwordx2 v[242:243], v4, s[76:79], 0 offen offset:160
    buffer_load_dwordx2 v[244:245], v4, s[76:79], 0 offen offset:192
    s_mov_b32 s40, s4
    s_mov_b32 s41, s5
    s_mov_b32 s42, 2097152
    s_mov_b32 s43, 0x20000
    s_mov_b32 s80, s32
    s_mov_b32 s81, s33
    s_mov_b32 s82, 1024
    s_mov_b32 s83, 0x20000
    s_lshl_b32 s92, s85, 3
    s_lshl_b32 s93, s84, 1
    s_add_u32 s92, s92, s93
    s_lshl_b32 s92, s92, 10
    v_lshlrev_b32 v12, 4, v1
    v_add_u32 v13, s92, v12
    buffer_load_dwordx4 v[208:211], v13, s[40:43], 0 offen
    buffer_load_dwordx4 v[212:215], v13, s[40:43], 0 offen offset:1024
    buffer_load_dwordx4 v[216:219], v12, s[80:83], 0 offen
    s_mov_b32 s56, s38
    s_mov_b32 s57, s39
    s_mov_b32 s58, 7340032
    s_mov_b32 s59, 0x20000
    s_add_u32 s68, s38, 10485760
    s_addc_u32 s69, s39, 0
    s_mov_b32 s70, 2097152
    s_mov_b32 s71, 0x20000
    s_mov_b32 s72, s34
    s_mov_b32 s73, s35
    s_mov_b32 s74, 2097152
    s_mov_b32 s75, 0x20000
    s_and_b32 s92, s2, 7
    s_lshl_b32 s92, s92, 5
    v_and_b32 v246, 31, v1
    v_add_u32 v246, s92, v246
    v_lshlrev_b32 v246, 2, v246
    v_add_u32 v246, 3072, v246
    s_waitcnt vmcnt(12)
    v_lshlrev_b32 v20, 16, v20
    v_lshlrev_b32 v21, 16, v21
    v_lshlrev_b32 v22, 16, v22
    v_lshlrev_b32 v23, 16, v23
    v_lshlrev_b32 v24, 16, v24
    v_lshlrev_b32 v25, 16, v25
    v_lshlrev_b32 v26, 16, v26
    v_mul_f32 v26, 0x3fb8aa3b, v26
    v_exp_f32 v26, v26
    s_nop 0
    v_cvt_pk_bf16_f32 v26, v26, v26
    v_lshlrev_b32 v26, 16, v26
    v_mul_f32 v20, v26, v20
    v_mul_f32 v21, v26, v21
    v_mul_f32 v20, 0x3fb8aa3b, v20
    v_mul_f32 v21, 0.15915494, v21
    v_mul_f32 v22, v26, v22
    v_mul_f32 v23, v26, v23
    v_mov_b32 v40, v20
    v_mov_b32 v41, v21
    v_mul_f32 v44, 0x41000000, v20
    v_mul_f32 v45, 0x41000000, v21
    v_mul_f32 v48, 0x43000000, v20
    v_mul_f32 v49, 0x43000000, v21
    v_exp_f32 v40, v40
    v_fract_f32 v41, v41
    v_exp_f32 v44, v44
    v_fract_f32 v45, v45
    v_exp_f32 v48, v48
    v_fract_f32 v49, v49
    v_pk_mul_f32 v[52:53], v[24:25], v[22:23] op_sel:[0,0] op_sel_hi:[1,0]
    v_pk_fma_f32 v[28:29], v[24:25], v[22:23], v[52:53] op_sel:[1,1,0] op_sel_hi:[0,1,1] neg_lo:[1,0,0]
    v_cos_f32 v42, v41
    v_sin_f32 v43, v41
    v_cos_f32 v46, v45
    v_sin_f32 v47, v45
    v_cos_f32 v50, v49
    v_sin_f32 v51, v49
    s_nop 0
    v_mul_f32 v30, v40, v42
    v_mul_f32 v31, v40, v43
    v_mul_f32 v36, v44, v46
    v_mul_f32 v37, v44, v47
    v_mul_f32 v38, v48, v50
    v_mul_f32 v39, v48, v51
    v_pk_mul_f32 v[52:53], v[30:31], v[30:31] op_sel:[0,0] op_sel_hi:[1,0]
    v_pk_fma_f32 v[32:33], v[30:31], v[30:31], v[52:53] op_sel:[1,1,0] op_sel_hi:[0,1,1] neg_lo:[1,0,0]
    v_pk_mul_f32 v[52:53], v[32:33], v[32:33] op_sel:[0,0] op_sel_hi:[1,0]
    v_pk_fma_f32 v[34:35], v[32:33], v[32:33], v[52:53] op_sel:[1,1,0] op_sel_hi:[0,1,1] neg_lo:[1,0,0]
    s_waitcnt vmcnt(11)
    v_readfirstlane_b32 s90, v6
    s_nop 3
    s_mul_i32 s90, s90, 0x9E3779B1
    s_add_u32 s90, s90, 0x7F4A7C15
    v_cvt_pk_bf16_f32 v104, v28, -v29
    ds_write_b32 v5, v104 offset:0
    v_cvt_pk_bf16_f32 v105, v36, v37
    ds_write_b32 v5, v105 offset:22176
    v_mov_b32 v119, 0x3f80
    ds_write_b32 v5, v119 offset:21648
    v_pk_mul_f32 v[120:121], v[28:29], v[38:39] op_sel:[0,0] op_sel_hi:[1,0]
    v_pk_mul_f32 v[122:123], v[36:37], v[36:37] op_sel:[0,0] op_sel_hi:[1,0]
    v_pk_mul_f32 v[124:125], v[28:29], v[30:31] op_sel:[0,0] op_sel_hi:[1,0]
    v_pk_fma_f32 v[56:57], v[28:29], v[38:39], v[120:121] op_sel:[1,1,0] op_sel_hi:[0,1,1] neg_lo:[1,0,0]
    v_pk_fma_f32 v[58:59], v[36:37], v[36:37], v[122:123] op_sel:[1,1,0] op_sel_hi:[0,1,1] neg_lo:[1,0,0]
    v_pk_fma_f32 v[60:61], v[28:29], v[30:31], v[124:125] op_sel:[1,1,0] op_sel_hi:[0,1,1] neg_lo:[1,0,0]
    v_pk_mul_f32 v[120:121], v[56:57], v[38:39] op_sel:[0,0] op_sel_hi:[1,0]
    v_pk_mul_f32 v[122:123], v[58:59], v[36:37] op_sel:[0,0] op_sel_hi:[1,0]
    v_pk_mul_f32 v[124:125], v[60:61], v[30:31] op_sel:[0,0] op_sel_hi:[1,0]
    v_pk_mul_f32 v[126:127], v[56:57], v[30:31] op_sel:[0,0] op_sel_hi:[1,0]
    v_cvt_pk_bf16_f32 v106, v56, -v57
    ds_write_b32 v5, v106 offset:4224
    v_cvt_pk_bf16_f32 v107, v58, v59
    ds_write_b32 v5, v107 offset:22704
    v_cvt_pk_bf16_f32 v108, v60, -v61
    ds_write_b32 v5, v108 offset:528
    v_pk_fma_f32 v[62:63], v[56:57], v[38:39], v[120:121] op_sel:[1,1,0] op_sel_hi:[0,1,1] neg_lo:[1,0,0]
    v_pk_fma_f32 v[64:65], v[58:59], v[36:37], v[122:123] op_sel:[1,1,0] op_sel_hi:[0,1,1] neg_lo:[1,0,0]
    v_pk_fma_f32 v[66:67], v[60:61], v[30:31], v[124:125] op_sel:[1,1,0] op_sel_hi:[0,1,1] neg_lo:[1,0,0]
    v_pk_fma_f32 v[68:69], v[56:57], v[30:31], v[126:127] op_sel:[1,1,0] op_sel_hi:[0,1,1] neg_lo:[1,0,0]
    v_pk_mul_f32 v[120:121], v[62:63], v[38:39] op_sel:[0,0] op_sel_hi:[1,0]
    v_pk_mul_f32 v[122:123], v[64:65], v[36:37] op_sel:[0,0] op_sel_hi:[1,0]
    v_pk_mul_f32 v[124:125], v[66:67], v[30:31] op_sel:[0,0] op_sel_hi:[1,0]
    v_pk_mul_f32 v[126:127], v[68:69], v[30:31] op_sel:[0,0] op_sel_hi:[1,0]
    v_pk_mul_f32 v[128:129], v[62:63], v[32:33] op_sel:[0,0] op_sel_hi:[1,0]
    v_cvt_pk_bf16_f32 v109, v62, -v63
    ds_write_b32 v5, v109 offset:8448
    v_cvt_pk_bf16_f32 v110, v64, v65
    ds_write_b32 v5, v110 offset:23232
    v_cvt_pk_bf16_f32 v111, v66, -v67
    ds_write_b32 v5, v111 offset:1056
    v_cvt_pk_bf16_f32 v112, v68, -v69
    ds_write_b32 v5, v112 offset:4752
    v_pk_fma_f32 v[70:71], v[62:63], v[38:39], v[120:121] op_sel:[1,1,0] op_sel_hi:[0,1,1] neg_lo:[1,0,0]
    v_pk_fma_f32 v[72:73], v[64:65], v[36:37], v[122:123] op_sel:[1,1,0] op_sel_hi:[0,1,1] neg_lo:[1,0,0]
    v_pk_fma_f32 v[74:75], v[66:67], v[30:31], v[124:125] op_sel:[1,1,0] op_sel_hi:[0,1,1] neg_lo:[1,0,0]
    v_pk_fma_f32 v[76:77], v[68:69], v[30:31], v[126:127] op_sel:[1,1,0] op_sel_hi:[0,1,1] neg_lo:[1,0,0]
    v_pk_fma_f32 v[78:79], v[62:63], v[32:33], v[128:129] op_sel:[1,1,0] op_sel_hi:[0,1,1] neg_lo:[1,0,0]
    v_pk_mul_f32 v[120:121], v[70:71], v[38:39] op_sel:[0,0] op_sel_hi:[1,0]
    v_pk_mul_f32 v[122:123], v[72:73], v[36:37] op_sel:[0,0] op_sel_hi:[1,0]
    v_pk_mul_f32 v[124:125], v[74:75], v[30:31] op_sel:[0,0] op_sel_hi:[1,0]
    v_pk_mul_f32 v[126:127], v[76:77], v[30:31] op_sel:[0,0] op_sel_hi:[1,0]
    v_pk_mul_f32 v[128:129], v[78:79], v[32:33] op_sel:[0,0] op_sel_hi:[1,0]
    v_pk_mul_f32 v[130:131], v[70:71], v[32:33] op_sel:[0,0] op_sel_hi:[1,0]
    v_cvt_pk_bf16_f32 v113, v70, -v71
    ds_write_b32 v5, v113 offset:10560
    v_cvt_pk_bf16_f32 v114, v72, v73
    ds_write_b32 v5, v114 offset:23760
    v_cvt_pk_bf16_f32 v115, v74, -v75
    ds_write_b32 v5, v115 offset:1584
    v_cvt_pk_bf16_f32 v116, v76, -v77
    ds_write_b32 v5, v116 offset:5280
    v_cvt_pk_bf16_f32 v117, v78, -v79
    ds_write_b32 v5, v117 offset:8976
    v_pk_fma_f32 v[80:81], v[70:71], v[38:39], v[120:121] op_sel:[1,1,0] op_sel_hi:[0,1,1] neg_lo:[1,0,0]
    v_pk_fma_f32 v[82:83], v[72:73], v[36:37], v[122:123] op_sel:[1,1,0] op_sel_hi:[0,1,1] neg_lo:[1,0,0]
    v_pk_fma_f32 v[84:85], v[74:75], v[30:31], v[124:125] op_sel:[1,1,0] op_sel_hi:[0,1,1] neg_lo:[1,0,0]
    v_pk_fma_f32 v[86:87], v[76:77], v[30:31], v[126:127] op_sel:[1,1,0] op_sel_hi:[0,1,1] neg_lo:[1,0,0]
    v_pk_fma_f32 v[88:89], v[78:79], v[32:33], v[128:129] op_sel:[1,1,0] op_sel_hi:[0,1,1] neg_lo:[1,0,0]
    v_pk_fma_f32 v[90:91], v[70:71], v[32:33], v[130:131] op_sel:[1,1,0] op_sel_hi:[0,1,1] neg_lo:[1,0,0]
    v_pk_mul_f32 v[120:121], v[80:81], v[38:39] op_sel:[0,0] op_sel_hi:[1,0]
    v_pk_mul_f32 v[122:123], v[82:83], v[36:37] op_sel:[0,0] op_sel_hi:[1,0]
    v_pk_mul_f32 v[124:125], v[84:85], v[30:31] op_sel:[0,0] op_sel_hi:[1,0]
    v_pk_mul_f32 v[126:127], v[86:87], v[30:31] op_sel:[0,0] op_sel_hi:[1,0]
    v_pk_mul_f32 v[128:129], v[88:89], v[32:33] op_sel:[0,0] op_sel_hi:[1,0]
    v_pk_mul_f32 v[130:131], v[90:91], v[32:33] op_sel:[0,0] op_sel_hi:[1,0]
    v_pk_mul_f32 v[132:133], v[80:81], v[34:35] op_sel:[0,0] op_sel_hi:[1,0]
    v_cvt_pk_bf16_f32 v104, v80, -v81
    ds_write_b32 v5, v104 offset:12672
    v_cvt_pk_bf16_f32 v105, v82, v83
    ds_write_b32 v5, v105 offset:24288
    v_cvt_pk_bf16_f32 v106, v84, -v85
    ds_write_b32 v5, v106 offset:2112
    v_cvt_pk_bf16_f32 v107, v86, -v87
    ds_write_b32 v5, v107 offset:5808
    v_cvt_pk_bf16_f32 v108, v88, -v89
    ds_write_b32 v5, v108 offset:9504
    v_cvt_pk_bf16_f32 v109, v90, -v91
    ds_write_b32 v5, v109 offset:11088
    v_pk_fma_f32 v[92:93], v[80:81], v[38:39], v[120:121] op_sel:[1,1,0] op_sel_hi:[0,1,1] neg_lo:[1,0,0]
    v_pk_fma_f32 v[94:95], v[82:83], v[36:37], v[122:123] op_sel:[1,1,0] op_sel_hi:[0,1,1] neg_lo:[1,0,0]
    v_pk_fma_f32 v[96:97], v[84:85], v[30:31], v[124:125] op_sel:[1,1,0] op_sel_hi:[0,1,1] neg_lo:[1,0,0]
    v_pk_fma_f32 v[98:99], v[86:87], v[30:31], v[126:127] op_sel:[1,1,0] op_sel_hi:[0,1,1] neg_lo:[1,0,0]
    v_pk_fma_f32 v[100:101], v[88:89], v[32:33], v[128:129] op_sel:[1,1,0] op_sel_hi:[0,1,1] neg_lo:[1,0,0]
    v_pk_fma_f32 v[102:103], v[90:91], v[32:33], v[130:131] op_sel:[1,1,0] op_sel_hi:[0,1,1] neg_lo:[1,0,0]
    v_pk_fma_f32 v[56:57], v[80:81], v[34:35], v[132:133] op_sel:[1,1,0] op_sel_hi:[0,1,1] neg_lo:[1,0,0]
    v_pk_mul_f32 v[120:121], v[92:93], v[38:39] op_sel:[0,0] op_sel_hi:[1,0]
    v_pk_mul_f32 v[122:123], v[94:95], v[36:37] op_sel:[0,0] op_sel_hi:[1,0]
    v_pk_mul_f32 v[124:125], v[96:97], v[30:31] op_sel:[0,0] op_sel_hi:[1,0]
    v_pk_mul_f32 v[126:127], v[98:99], v[30:31] op_sel:[0,0] op_sel_hi:[1,0]
    v_pk_mul_f32 v[128:129], v[102:103], v[32:33] op_sel:[0,0] op_sel_hi:[1,0]
    v_pk_mul_f32 v[130:131], v[92:93], v[34:35] op_sel:[0,0] op_sel_hi:[1,0]
    v_cvt_pk_bf16_f32 v110, v92, -v93
    ds_write_b32 v5, v110 offset:13728
    v_cvt_pk_bf16_f32 v111, v94, v95
    ds_write_b32 v5, v111 offset:24816
    v_cvt_pk_bf16_f32 v112, v96, -v97
    ds_write_b32 v5, v112 offset:2640
    v_cvt_pk_bf16_f32 v113, v98, -v99
    ds_write_b32 v5, v113 offset:6336
    v_cvt_pk_bf16_f32 v114, v100, -v101
    ds_write_b32 v5, v114 offset:10032
    v_cvt_pk_bf16_f32 v115, v102, -v103
    ds_write_b32 v5, v115 offset:11616
    v_cvt_pk_bf16_f32 v116, v56, -v57
    ds_write_b32 v5, v116 offset:13200
    v_pk_fma_f32 v[58:59], v[92:93], v[38:39], v[120:121] op_sel:[1,1,0] op_sel_hi:[0,1,1] neg_lo:[1,0,0]
    v_pk_fma_f32 v[60:61], v[94:95], v[36:37], v[122:123] op_sel:[1,1,0] op_sel_hi:[0,1,1] neg_lo:[1,0,0]
    v_pk_fma_f32 v[62:63], v[96:97], v[30:31], v[124:125] op_sel:[1,1,0] op_sel_hi:[0,1,1] neg_lo:[1,0,0]
    v_pk_fma_f32 v[64:65], v[98:99], v[30:31], v[126:127] op_sel:[1,1,0] op_sel_hi:[0,1,1] neg_lo:[1,0,0]
    v_pk_fma_f32 v[66:67], v[102:103], v[32:33], v[128:129] op_sel:[1,1,0] op_sel_hi:[0,1,1] neg_lo:[1,0,0]
    v_pk_fma_f32 v[68:69], v[92:93], v[34:35], v[130:131] op_sel:[1,1,0] op_sel_hi:[0,1,1] neg_lo:[1,0,0]
    v_pk_mul_f32 v[120:121], v[58:59], v[38:39] op_sel:[0,0] op_sel_hi:[1,0]
    v_pk_mul_f32 v[122:123], v[60:61], v[36:37] op_sel:[0,0] op_sel_hi:[1,0]
    v_pk_mul_f32 v[124:125], v[62:63], v[30:31] op_sel:[0,0] op_sel_hi:[1,0]
    v_pk_mul_f32 v[126:127], v[64:65], v[30:31] op_sel:[0,0] op_sel_hi:[1,0]
    v_pk_mul_f32 v[128:129], v[58:59], v[34:35] op_sel:[0,0] op_sel_hi:[1,0]
    v_cvt_pk_bf16_f32 v117, v58, -v59
    ds_write_b32 v5, v117 offset:14784
    v_cvt_pk_bf16_f32 v104, v60, v61
    ds_write_b32 v5, v104 offset:25344
    v_cvt_pk_bf16_f32 v105, v62, -v63
    ds_write_b32 v5, v105 offset:3168
    v_cvt_pk_bf16_f32 v106, v64, -v65
    ds_write_b32 v5, v106 offset:6864
    v_cvt_pk_bf16_f32 v107, v66, -v67
    ds_write_b32 v5, v107 offset:12144
    v_cvt_pk_bf16_f32 v108, v68, -v69
    ds_write_b32 v5, v108 offset:14256
    v_pk_fma_f32 v[70:71], v[58:59], v[38:39], v[120:121] op_sel:[1,1,0] op_sel_hi:[0,1,1] neg_lo:[1,0,0]
    v_pk_fma_f32 v[72:73], v[60:61], v[36:37], v[122:123] op_sel:[1,1,0] op_sel_hi:[0,1,1] neg_lo:[1,0,0]
    v_pk_fma_f32 v[74:75], v[62:63], v[30:31], v[124:125] op_sel:[1,1,0] op_sel_hi:[0,1,1] neg_lo:[1,0,0]
    v_pk_fma_f32 v[76:77], v[64:65], v[30:31], v[126:127] op_sel:[1,1,0] op_sel_hi:[0,1,1] neg_lo:[1,0,0]
    v_pk_fma_f32 v[78:79], v[58:59], v[34:35], v[128:129] op_sel:[1,1,0] op_sel_hi:[0,1,1] neg_lo:[1,0,0]
    v_pk_mul_f32 v[120:121], v[70:71], v[38:39] op_sel:[0,0] op_sel_hi:[1,0]
    v_pk_mul_f32 v[122:123], v[72:73], v[36:37] op_sel:[0,0] op_sel_hi:[1,0]
    v_pk_mul_f32 v[124:125], v[76:77], v[30:31] op_sel:[0,0] op_sel_hi:[1,0]
    v_pk_mul_f32 v[126:127], v[70:71], v[34:35] op_sel:[0,0] op_sel_hi:[1,0]
    v_cvt_pk_bf16_f32 v109, v70, -v71
    ds_write_b32 v5, v109 offset:15840
    v_cvt_pk_bf16_f32 v110, v72, v73
    ds_write_b32 v5, v110 offset:25872
    v_cvt_pk_bf16_f32 v111, v74, -v75
    ds_write_b32 v5, v111 offset:3696
    v_cvt_pk_bf16_f32 v112, v76, -v77
    ds_write_b32 v5, v112 offset:7392
    v_cvt_pk_bf16_f32 v113, v78, -v79
    ds_write_b32 v5, v113 offset:15312
    v_pk_fma_f32 v[80:81], v[70:71], v[38:39], v[120:121] op_sel:[1,1,0] op_sel_hi:[0,1,1] neg_lo:[1,0,0]
    v_pk_fma_f32 v[82:83], v[72:73], v[36:37], v[122:123] op_sel:[1,1,0] op_sel_hi:[0,1,1] neg_lo:[1,0,0]
    v_pk_fma_f32 v[84:85], v[76:77], v[30:31], v[124:125] op_sel:[1,1,0] op_sel_hi:[0,1,1] neg_lo:[1,0,0]
    v_pk_fma_f32 v[86:87], v[70:71], v[34:35], v[126:127] op_sel:[1,1,0] op_sel_hi:[0,1,1] neg_lo:[1,0,0]
    v_pk_mul_f32 v[120:121], v[80:81], v[38:39] op_sel:[0,0] op_sel_hi:[1,0]
    v_pk_mul_f32 v[122:123], v[82:83], v[36:37] op_sel:[0,0] op_sel_hi:[1,0]
    v_cvt_pk_bf16_f32 v114, v80, -v81
    ds_write_b32 v5, v114 offset:16896
    v_cvt_pk_bf16_f32 v115, v82, v83
    ds_write_b32 v5, v115 offset:26400
    v_cvt_pk_bf16_f32 v116, v84, -v85
    ds_write_b32 v5, v116 offset:7920
    v_cvt_pk_bf16_f32 v117, v86, -v87
    ds_write_b32 v5, v117 offset:16368
    v_pk_fma_f32 v[88:89], v[80:81], v[38:39], v[120:121] op_sel:[1,1,0] op_sel_hi:[0,1,1] neg_lo:[1,0,0]
    v_pk_fma_f32 v[90:91], v[82:83], v[36:37], v[122:123] op_sel:[1,1,0] op_sel_hi:[0,1,1] neg_lo:[1,0,0]
    v_pk_mul_f32 v[120:121], v[88:89], v[38:39] op_sel:[0,0] op_sel_hi:[1,0]
    v_pk_mul_f32 v[122:123], v[90:91], v[36:37] op_sel:[0,0] op_sel_hi:[1,0]
    v_cvt_pk_bf16_f32 v104, v88, -v89
    ds_write_b32 v5, v104 offset:17424
    v_cvt_pk_bf16_f32 v105, v90, v91
    ds_write_b32 v5, v105 offset:26928
    v_pk_fma_f32 v[92:93], v[88:89], v[38:39], v[120:121] op_sel:[1,1,0] op_sel_hi:[0,1,1] neg_lo:[1,0,0]
    v_pk_fma_f32 v[94:95], v[90:91], v[36:37], v[122:123] op_sel:[1,1,0] op_sel_hi:[0,1,1] neg_lo:[1,0,0]
    v_pk_mul_f32 v[120:121], v[92:93], v[38:39] op_sel:[0,0] op_sel_hi:[1,0]
    v_pk_mul_f32 v[122:123], v[94:95], v[36:37] op_sel:[0,0] op_sel_hi:[1,0]
    v_cvt_pk_bf16_f32 v106, v92, -v93
    ds_write_b32 v5, v106 offset:17952
    v_cvt_pk_bf16_f32 v107, v94, v95
    ds_write_b32 v5, v107 offset:27456
    v_pk_fma_f32 v[96:97], v[92:93], v[38:39], v[120:121] op_sel:[1,1,0] op_sel_hi:[0,1,1] neg_lo:[1,0,0]
    v_pk_fma_f32 v[98:99], v[94:95], v[36:37], v[122:123] op_sel:[1,1,0] op_sel_hi:[0,1,1] neg_lo:[1,0,0]
    v_pk_mul_f32 v[120:121], v[96:97], v[38:39] op_sel:[0,0] op_sel_hi:[1,0]
    v_pk_mul_f32 v[122:123], v[98:99], v[36:37] op_sel:[0,0] op_sel_hi:[1,0]
    v_cvt_pk_bf16_f32 v108, v96, -v97
    ds_write_b32 v5, v108 offset:18480
    v_cvt_pk_bf16_f32 v109, v98, v99
    ds_write_b32 v5, v109 offset:27984
    v_pk_fma_f32 v[100:101], v[96:97], v[38:39], v[120:121] op_sel:[1,1,0] op_sel_hi:[0,1,1] neg_lo:[1,0,0]
    v_pk_fma_f32 v[102:103], v[98:99], v[36:37], v[122:123] op_sel:[1,1,0] op_sel_hi:[0,1,1] neg_lo:[1,0,0]
    v_pk_mul_f32 v[120:121], v[100:101], v[38:39] op_sel:[0,0] op_sel_hi:[1,0]
    v_pk_mul_f32 v[122:123], v[102:103], v[36:37] op_sel:[0,0] op_sel_hi:[1,0]
    v_cvt_pk_bf16_f32 v110, v100, -v101
    ds_write_b32 v5, v110 offset:19008
    v_cvt_pk_bf16_f32 v111, v102, v103
    ds_write_b32 v5, v111 offset:28512
    v_pk_fma_f32 v[56:57], v[100:101], v[38:39], v[120:121] op_sel:[1,1,0] op_sel_hi:[0,1,1] neg_lo:[1,0,0]
    v_pk_fma_f32 v[58:59], v[102:103], v[36:37], v[122:123] op_sel:[1,1,0] op_sel_hi:[0,1,1] neg_lo:[1,0,0]
    v_pk_mul_f32 v[120:121], v[56:57], v[38:39] op_sel:[0,0] op_sel_hi:[1,0]
    v_pk_mul_f32 v[122:123], v[58:59], v[36:37] op_sel:[0,0] op_sel_hi:[1,0]
    v_cvt_pk_bf16_f32 v112, v56, -v57
    ds_write_b32 v5, v112 offset:19536
    v_cvt_pk_bf16_f32 v113, v58, v59
    ds_write_b32 v5, v113 offset:29040
    v_pk_fma_f32 v[60:61], v[56:57], v[38:39], v[120:121] op_sel:[1,1,0] op_sel_hi:[0,1,1] neg_lo:[1,0,0]
    v_pk_fma_f32 v[62:63], v[58:59], v[36:37], v[122:123] op_sel:[1,1,0] op_sel_hi:[0,1,1] neg_lo:[1,0,0]
    v_pk_mul_f32 v[120:121], v[60:61], v[38:39] op_sel:[0,0] op_sel_hi:[1,0]
    v_cvt_pk_bf16_f32 v114, v60, -v61
    ds_write_b32 v5, v114 offset:20064
    v_cvt_pk_bf16_f32 v115, v62, v63
    ds_write_b32 v5, v115 offset:29568
    v_pk_fma_f32 v[64:65], v[60:61], v[38:39], v[120:121] op_sel:[1,1,0] op_sel_hi:[0,1,1] neg_lo:[1,0,0]
    v_pk_mul_f32 v[120:121], v[64:65], v[38:39] op_sel:[0,0] op_sel_hi:[1,0]
    v_cvt_pk_bf16_f32 v116, v64, -v65
    ds_write_b32 v5, v116 offset:20592
    v_pk_fma_f32 v[66:67], v[64:65], v[38:39], v[120:121] op_sel:[1,1,0] op_sel_hi:[0,1,1] neg_lo:[1,0,0]
    v_cvt_pk_bf16_f32 v117, v66, -v67
    ds_write_b32 v5, v117 offset:21120
    s_lshr_b32 s94, s84, 1
    s_mul_i32 s95, s94, 1568
    s_add_u32 s95, s95, 159520
    v_mov_b32 v20, 0
    v_mov_b32 v21, 0
    v_mov_b32 v22, 0
    v_mov_b32 v23, 0
    v_mov_b32 v12, s95
    ds_write_b128 v12, v[20:23]
    v_mul_u32_u24 v14, 528, v10
    v_lshl_add_u32 v14, v11, 4, v14
    s_mul_i32 s94, s94, 30096
    s_add_u32 s94, s94, 90112
    v_add_u32 v14, s94, v14
    s_waitcnt lgkmcnt(0)
    s_add_u32 s92, s90, 1
    s_lshl_b32 s93, s84, 2
    s_add_u32 s93, s93, 162656
    v_mov_b32 v12, s93
    v_mov_b32 v13, s92
    ds_write_b32 v12, v13
    v_and_b32 v12, 3, v1
    v_lshlrev_b32 v12, 2, v12
    v_add_u32 v12, 162656, v12
    s_mov_b32 s53, 1600000
lsync_3:
    ds_read_b32 v13, v12
    s_waitcnt lgkmcnt(0)
    v_cmp_ne_u32 vcc, s92, v13
    s_cmp_eq_u64 vcc, 0
    s_cbranch_scc1 lsyncd_4
    s_sub_u32 s53, s53, 1
    s_cmp_lg_u32 s53, 0
    s_cbranch_scc1 lsync_3
lsyncd_4:
    s_bitcmp1_b32 s84, 0
    s_cbranch_scc1 b1_5
    ds_read_b128 v[48:51], v14 offset:21648
    ds_read_b128 v[80:83], v14 offset:0
    ds_read_b128 v[112:115], v14 offset:16896
    ds_read_b128 v[52:55], v14 offset:21712
    ds_read_b128 v[84:87], v14 offset:64
    ds_read_b128 v[116:119], v14 offset:16960
    ds_read_b128 v[56:59], v14 offset:21776
    ds_read_b128 v[88:91], v14 offset:128
    ds_read_b128 v[120:123], v14 offset:17024
    ds_read_b128 v[60:63], v14 offset:21840
    ds_read_b128 v[92:95], v14 offset:192
    ds_read_b128 v[124:127], v14 offset:17088
    ds_read_b128 v[64:67], v14 offset:21904
    ds_read_b128 v[96:99], v14 offset:256
    ds_read_b128 v[128:131], v14 offset:17152
    ds_read_b128 v[68:71], v14 offset:21968
    ds_read_b128 v[100:103], v14 offset:320
    ds_read_b128 v[132:135], v14 offset:17216
    ds_read_b128 v[72:75], v14 offset:22032
    ds_read_b128 v[104:107], v14 offset:384
    ds_read_b128 v[136:139], v14 offset:17280
    ds_read_b128 v[76:79], v14 offset:22096
    ds_read_b128 v[108:111], v14 offset:448
    ds_read_b128 v[140:143], v14 offset:17344
    v_lshrrev_b32 v15, 1, v11
    v_lshlrev_b32 v15, 8, v15
    v_lshl_add_u32 v15, v10, 4, v15
    v_and_b32 v16, 1, v11
    v_lshl_add_u32 v15, v16, 3, v15
    v_add_u32 v15, s95, v15
    v_lshlrev_b32 v16, 7, v11
    v_lshl_add_u32 v16, v10, 1, v16
    v_add_u32 v16, s95, v16
    s_waitcnt lgkmcnt(15)
    v_mfma_f32_16x16x32_bf16 v[144:147], v[80:83], v[48:51], 0
    v_mfma_f32_16x16x32_bf16 v[148:151], v[112:115], v[48:51], 0
    s_waitcnt lgkmcnt(15)
    v_mfma_f32_16x16x32_bf16 v[144:147], v[84:87], v[52:55], v[144:147]
    v_mfma_f32_16x16x32_bf16 v[148:151], v[116:119], v[52:55], v[148:151]
    s_waitcnt lgkmcnt(15)
    v_mfma_f32_16x16x32_bf16 v[144:147], v[88:91], v[56:59], v[144:147]
    v_mfma_f32_16x16x32_bf16 v[148:151], v[120:123], v[56:59], v[148:151]
    s_waitcnt lgkmcnt(12)
    v_mfma_f32_16x16x32_bf16 v[144:147], v[92:95], v[60:63], v[144:147]
    v_mfma_f32_16x16x32_bf16 v[148:151], v[124:127], v[60:63], v[148:151]
    s_waitcnt lgkmcnt(9)
    v_mfma_f32_16x16x32_bf16 v[144:147], v[96:99], v[64:67], v[144:147]
    v_mfma_f32_16x16x32_bf16 v[148:151], v[128:131], v[64:67], v[148:151]
    s_waitcnt lgkmcnt(6)
    v_mfma_f32_16x16x32_bf16 v[144:147], v[100:103], v[68:71], v[144:147]
    v_mfma_f32_16x16x32_bf16 v[148:151], v[132:135], v[68:71], v[148:151]
    s_waitcnt lgkmcnt(3)
    v_mfma_f32_16x16x32_bf16 v[144:147], v[104:107], v[72:75], v[144:147]
    v_mfma_f32_16x16x32_bf16 v[148:151], v[136:139], v[72:75], v[148:151]
    s_waitcnt lgkmcnt(0)
    v_mfma_f32_16x16x32_bf16 v[144:147], v[108:111], v[76:79], v[144:147]
    v_mfma_f32_16x16x32_bf16 v[148:151], v[140:143], v[76:79], v[148:151]
    s_nop 7
    v_cvt_pk_bf16_f32 v152, v144, v145
    v_cvt_pk_bf16_f32 v153, v146, v147
    v_cvt_pk_bf16_f32 v154, v148, v149
    v_cvt_pk_bf16_f32 v155, v150, v151
    ds_write_b64 v15, v[152:153] offset:16
    ds_write_b16 v16, v154 offset:1040
    ds_write_b16_d16_hi v16, v154 offset:1072
    ds_write_b16 v16, v155 offset:1104
    ds_write_b16_d16_hi v16, v155 offset:1136
    s_branch bj_6
b1_5:
    ds_read_b128 v[48:51], v14 offset:21648
    ds_read_b128 v[80:83], v14 offset:8448
    ds_read_b128 v[52:55], v14 offset:21712
    ds_read_b128 v[84:87], v14 offset:8512
    ds_read_b128 v[56:59], v14 offset:21776
    ds_read_b128 v[88:91], v14 offset:8576
    ds_read_b128 v[60:63], v14 offset:21840
    ds_read_b128 v[92:95], v14 offset:8640
    ds_read_b128 v[64:67], v14 offset:21904
    ds_read_b128 v[96:99], v14 offset:8704
    ds_read_b128 v[68:71], v14 offset:21968
    ds_read_b128 v[100:103], v14 offset:8768
    ds_read_b128 v[72:75], v14 offset:22032
    ds_read_b128 v[104:107], v14 offset:8832
    ds_read_b128 v[76:79], v14 offset:22096
    ds_read_b128 v[108:111], v14 offset:8896
    v_cmp_gt_u32 vcc, 2, v11
    v_lshlrev_b32 v15, 7, v11
    v_lshlrev_b32 v16, 3, v10
    v_lshlrev_b32 v17, 2, v10
    v_cndmask_b32 v16, v17, v16, vcc
    v_add_u32 v15, v15, v16
    v_add_u32 v15, s95, v15
    v_mov_b32 v17, 64
    v_mov_b32 v18, 4
    v_cndmask_b32 v16, v17, v18, vcc
    v_add_u32 v16, v15, v16
    s_waitcnt lgkmcnt(14)
    v_mfma_f32_16x16x32_bf16 v[144:147], v[80:83], v[48:51], 0
    s_waitcnt lgkmcnt(12)
    v_mfma_f32_16x16x32_bf16 v[148:151], v[84:87], v[52:55], 0
    s_waitcnt lgkmcnt(10)
    v_mfma_f32_16x16x32_bf16 v[144:147], v[88:91], v[56:59], v[144:147]
    s_waitcnt lgkmcnt(8)
    v_mfma_f32_16x16x32_bf16 v[148:151], v[92:95], v[60:63], v[148:151]
    s_waitcnt lgkmcnt(6)
    v_mfma_f32_16x16x32_bf16 v[144:147], v[96:99], v[64:67], v[144:147]
    s_waitcnt lgkmcnt(4)
    v_mfma_f32_16x16x32_bf16 v[148:151], v[100:103], v[68:71], v[148:151]
    s_waitcnt lgkmcnt(2)
    v_mfma_f32_16x16x32_bf16 v[144:147], v[104:107], v[72:75], v[144:147]
    s_waitcnt lgkmcnt(0)
    v_mfma_f32_16x16x32_bf16 v[148:151], v[108:111], v[76:79], v[148:151]
    s_nop 7
    v_add_f32 v144, v144, v148
    v_add_f32 v145, v145, v149
    v_add_f32 v146, v146, v150
    v_add_f32 v147, v147, v151
    v_cvt_pk_bf16_f32 v152, v144, v145
    v_cvt_pk_bf16_f32 v153, v146, v147
    ds_write_b32 v15, v152 offset:528
    ds_write_b32 v16, v153 offset:528
bj_6:
    s_waitcnt lgkmcnt(0)
    s_add_u32 s92, s90, 2
    s_lshl_b32 s93, s84, 2
    s_add_u32 s93, s93, 162672
    v_mov_b32 v12, s93
    v_mov_b32 v13, s92
    ds_write_b32 v12, v13
    v_and_b32 v12, 3, v1
    v_lshlrev_b32 v12, 2, v12
    v_add_u32 v12, 162672, v12
    s_mov_b32 s53, 1600000
lsync_7:
    ds_read_b32 v13, v12
    s_waitcnt lgkmcnt(0)
    v_cmp_ne_u32 vcc, s92, v13
    s_cmp_eq_u64 vcc, 0
    s_cbranch_scc1 lsyncd_8
    s_sub_u32 s53, s53, 1
    s_cmp_lg_u32 s53, 0
    s_cbranch_scc1 lsync_7
lsyncd_8:
    s_mov_b32 s76, 0x05040100
    s_mov_b32 s77, 0x07060100
    s_mov_b32 s78, 0x05040302
    s_mov_b32 s79, 0x07060302
    s_bitcmp1_b32 s84, 0
    s_cbranch_scc1 b1_9
    v_lshlrev_b32 v12, 5, v1
    v_add_u32 v12, s95, v12
    v_subrev_u32 v13, 16, v1
    v_lshlrev_b32 v14, 4, v13
    v_add_u32 v14, s95, v14
    v_subrev_u32 v15, 32, v1
    v_lshlrev_b32 v15, 3, v15
    v_add_u32 v15, s95, v15
    s_mov_b64 exec, 0xffff
    ds_read_b32 v64, v12 offset:12
    ds_read_b128 v[68:71], v12 offset:16
    ds_read_b128 v[72:75], v12 offset:32
    s_mov_b32 exec_lo, 0xffff0000
    ds_read_b32 v64, v14 offset:524
    ds_read_b128 v[68:71], v14 offset:528
    ds_read_b32 v72, v14 offset:544
    s_mov_b32 exec_lo, 0
    s_mov_b32 exec_hi, -1
    ds_read_b64 v[68:69], v15 offset:784
    ds_read_b32 v70, v15 offset:792
    s_waitcnt lgkmcnt(0)
    v_perm_b32 v48, v69, v70, s77
    v_perm_b32 v56, v70, v70, s76
    v_perm_b32 v49, v69, v69, s79
    v_perm_b32 v57, v69, v69, s79
    v_perm_b32 v50, v69, v69, s76
    v_perm_b32 v58, v69, v69, s78
    v_perm_b32 v51, v69, v69, s76
    v_perm_b32 v59, v69, v69, s76
    v_perm_b32 v52, v68, v69, s77
    v_perm_b32 v60, v69, v69, s76
    v_perm_b32 v53, v68, v68, s79
    v_perm_b32 v61, v68, v68, s79
    v_perm_b32 v54, v68, v68, s76
    v_perm_b32 v62, v68, v68, s78
    v_perm_b32 v55, v68, v68, s76
    v_perm_b32 v63, v68, v68, s76
    s_mov_b32 exec_lo, 0xffff0000
    s_mov_b32 exec_hi, 0
    v_cmp_eq_u32 vcc, 0, v13
    v_lshlrev_b32 v65, 16, v68
    s_nop 0
    v_cndmask_b32 v64, v65, v64, vcc
    v_perm_b32 v48, v71, v71, s78
    v_perm_b32 v56, v71, v72, s77
    v_perm_b32 v49, v71, v71, s76
    v_perm_b32 v57, v71, v71, s76
    v_perm_b32 v50, v70, v70, s78
    v_perm_b32 v58, v70, v71, s77
    v_perm_b32 v51, v70, v70, s76
    v_perm_b32 v59, v70, v70, s76
    v_perm_b32 v52, v69, v69, s78
    v_perm_b32 v60, v69, v70, s77
    v_perm_b32 v53, v69, v69, s76
    v_perm_b32 v61, v69, v69, s76
    v_perm_b32 v54, v68, v68, s78
    v_perm_b32 v62, v68, v69, s77
    v_perm_b32 v55, v64, v68, s77
    v_perm_b32 v63, v68, v68, s76
    s_mov_b32 exec_lo, 0xffff
    v_perm_b32 v48, v74, v75, s77
    v_perm_b32 v56, v75, v75, s78
    v_perm_b32 v49, v73, v74, s77
    v_perm_b32 v57, v74, v74, s78
    v_perm_b32 v50, v72, v73, s77
    v_perm_b32 v58, v73, v73, s78
    v_perm_b32 v51, v71, v72, s77
    v_perm_b32 v59, v72, v72, s78
    v_perm_b32 v52, v70, v71, s77
    v_perm_b32 v60, v71, v71, s78
    v_perm_b32 v53, v69, v70, s77
    v_perm_b32 v61, v70, v70, s78
    v_perm_b32 v54, v68, v69, s77
    v_perm_b32 v62, v69, v69, s78
    v_perm_b32 v55, v64, v68, s77
    v_perm_b32 v63, v68, v68, s78
    s_mov_b64 exec, -1
    v_mov_b32 v12, v1
    s_branch bj_10
b1_9:
    v_lshlrev_b32 v13, 2, v1
    v_add_u32 v13, s95, v13
    ds_read_b32 v68, v13 offset:1040
    ds_read_b32 v69, v13 offset:1044
    s_waitcnt lgkmcnt(0)
    v_perm_b32 v48, v69, v69, s76
    v_perm_b32 v56, v69, v69, s76
    v_perm_b32 v49, v68, v69, s77
    v_perm_b32 v57, v69, v69, s76
    v_perm_b32 v50, v68, v68, s79
    v_perm_b32 v58, v68, v68, s79
    v_perm_b32 v51, v68, v68, s79
    v_perm_b32 v59, v68, v68, s79
    v_perm_b32 v52, v68, v68, s79
    v_perm_b32 v60, v68, v68, s79
    v_perm_b32 v53, v68, v68, s76
    v_perm_b32 v61, v68, v68, s78
    v_perm_b32 v54, v68, v68, s76
    v_perm_b32 v62, v68, v68, s76
    v_perm_b32 v55, v68, v68, s76
    v_perm_b32 v63, v68, v68, s76
    v_add_u32 v12, 64, v1
bj_10:
    s_lshr_b32 s92, s84, 1
    s_mul_i32 s92, s92, 8320
    s_add_u32 s92, s92, 131072
    s_add_u32 s93, s92, 4064
    v_lshlrev_b32 v12, 5, v12
    v_sub_u32 v12, s93, v12
    ds_write_b128 v12, v[48:51]
    ds_write_b128 v12, v[52:55] offset:16
    ds_write_b128 v12, v[56:59] offset:4160
    ds_write_b128 v12, v[60:63] offset:4176
    v_and_b32 v13, 7, v1
    v_lshlrev_b32 v13, 2, v13
    v_add_u32 v13, s92, v13
    v_mov_b32 v14, 0
    ds_write_b32 v13, v14 offset:4096
    ds_write_b32 v13, v14 offset:8256
    v_lshrrev_b32 v12, 2, v1
    v_mul_u32_u24 v12, 224, v12
    v_and_b32 v13, 3, v1
    v_lshl_add_u32 v2, v13, 3, v12
    v_add_u32 v2, 32768, v2
    v_add_u32 v3, 73728, v2
    v_lshrrev_b32 v12, 1, v10
    v_xor_b32 v12, v12, v11
    v_lshlrev_b32 v12, 4, v12
    v_lshl_add_u32 v12, v10, 7, v12
    s_lshl_b32 s92, s84, 12
    v_add_u32 v4, s92, v12
    v_xor_b32 v5, 64, v4
    v_add_u32 v6, 90112, v4
    v_add_u32 v7, 90112, v5
    s_waitcnt vmcnt(3)
    s_mov_b32 s92, 0xffff0000
    v_lshlrev_b32 v20, 16, v232
    v_and_b32 v21, s92, v232
    v_lshlrev_b32 v24, 16, v232
    v_and_b32 v25, s92, v232
    v_lshlrev_b32 v22, 16, v233
    v_and_b32 v23, s92, v233
    v_lshlrev_b32 v26, 16, v233
    v_and_b32 v27, s92, v233
    v_lshlrev_b32 v28, 16, v234
    v_and_b32 v29, s92, v234
    v_lshlrev_b32 v32, 16, v234
    v_and_b32 v33, s92, v234
    v_lshlrev_b32 v30, 16, v235
    v_and_b32 v31, s92, v235
    v_lshlrev_b32 v34, 16, v235
    v_and_b32 v35, s92, v235
    v_lshlrev_b32 v36, 16, v236
    v_and_b32 v37, s92, v236
    v_lshlrev_b32 v40, 16, v236
    v_and_b32 v41, s92, v236
    v_lshlrev_b32 v38, 16, v237
    v_and_b32 v39, s92, v237
    v_lshlrev_b32 v42, 16, v237
    v_and_b32 v43, s92, v237
    v_lshlrev_b32 v44, 16, v238
    v_and_b32 v45, s92, v238
    v_lshlrev_b32 v48, 16, v238
    v_and_b32 v49, s92, v238
    v_lshlrev_b32 v46, 16, v239
    v_and_b32 v47, s92, v239
    v_lshlrev_b32 v50, 16, v239
    v_and_b32 v51, s92, v239
    v_lshlrev_b32 v52, 16, v240
    v_and_b32 v53, s92, v240
    v_lshlrev_b32 v56, 16, v240
    v_and_b32 v57, s92, v240
    v_lshlrev_b32 v54, 16, v241
    v_and_b32 v55, s92, v241
    v_lshlrev_b32 v58, 16, v241
    v_and_b32 v59, s92, v241
    v_lshlrev_b32 v60, 16, v242
    v_and_b32 v61, s92, v242
    v_lshlrev_b32 v64, 16, v242
    v_and_b32 v65, s92, v242
    v_lshlrev_b32 v62, 16, v243
    v_and_b32 v63, s92, v243
    v_lshlrev_b32 v66, 16, v243
    v_and_b32 v67, s92, v243
    v_lshlrev_b32 v68, 16, v244
    v_and_b32 v69, s92, v244
    v_lshlrev_b32 v72, 16, v244
    v_and_b32 v73, s92, v244
    v_lshlrev_b32 v70, 16, v245
    v_and_b32 v71, s92, v245
    v_lshlrev_b32 v74, 16, v245
    v_and_b32 v75, s92, v245
    s_waitcnt lgkmcnt(0)
    s_barrier
    ds_read_b128 v[132:135], v4 offset:0
    ds_read_b128 v[136:139], v4 offset:2048
    ds_read_b128 v[140:143], v5 offset:0
    ds_read_b128 v[144:147], v5 offset:2048
    ds_read_b64_tr_b16 v[76:77], v2 offset:0
    ds_read_b64_tr_b16 v[78:79], v2 offset:3584
    ds_read_b64_tr_b16 v[80:81], v2 offset:32
    ds_read_b64_tr_b16 v[82:83], v2 offset:3616
    ds_read_b64_tr_b16 v[84:85], v2 offset:64
    ds_read_b64_tr_b16 v[86:87], v2 offset:3648
    ds_read_b64_tr_b16 v[88:89], v2 offset:96
    ds_read_b64_tr_b16 v[90:91], v2 offset:3680
    ds_read_b64_tr_b16 v[92:93], v2 offset:128
    ds_read_b64_tr_b16 v[94:95], v2 offset:3712
    ds_read_b64_tr_b16 v[96:97], v2 offset:160
    ds_read_b64_tr_b16 v[98:99], v2 offset:3744
    ds_read_b64_tr_b16 v[100:101], v2 offset:192
    ds_read_b64_tr_b16 v[102:103], v2 offset:3776
    s_waitcnt lgkmcnt(0)
    v_mfma_f32_16x16x32_bf16 v[20:23], v[76:79], v[132:135], v[20:23]
    ds_read_b64_tr_b16 v[104:105], v2 offset:7168
    ds_read_b64_tr_b16 v[106:107], v2 offset:10752
    v_mfma_f32_16x16x32_bf16 v[24:27], v[76:79], v[136:139], v[24:27]
    ds_read_b64_tr_b16 v[108:109], v2 offset:7200
    ds_read_b64_tr_b16 v[110:111], v2 offset:10784
    v_mfma_f32_16x16x32_bf16 v[28:31], v[80:83], v[132:135], v[28:31]
    ds_read_b64_tr_b16 v[112:113], v2 offset:7232
    ds_read_b64_tr_b16 v[114:115], v2 offset:10816
    v_mfma_f32_16x16x32_bf16 v[32:35], v[80:83], v[136:139], v[32:35]
    ds_read_b64_tr_b16 v[116:117], v2 offset:7264
    ds_read_b64_tr_b16 v[118:119], v2 offset:10848
    v_mfma_f32_16x16x32_bf16 v[36:39], v[84:87], v[132:135], v[36:39]
    ds_read_b64_tr_b16 v[120:121], v2 offset:7296
    ds_read_b64_tr_b16 v[122:123], v2 offset:10880
    v_mfma_f32_16x16x32_bf16 v[40:43], v[84:87], v[136:139], v[40:43]
    ds_read_b64_tr_b16 v[124:125], v2 offset:7328
    ds_read_b64_tr_b16 v[126:127], v2 offset:10912
    v_mfma_f32_16x16x32_bf16 v[44:47], v[88:91], v[132:135], v[44:47]
    ds_read_b64_tr_b16 v[128:129], v2 offset:7360
    ds_read_b64_tr_b16 v[130:131], v2 offset:10944
    v_mfma_f32_16x16x32_bf16 v[48:51], v[88:91], v[136:139], v[48:51]
    v_mfma_f32_16x16x32_bf16 v[52:55], v[92:95], v[132:135], v[52:55]
    v_mfma_f32_16x16x32_bf16 v[56:59], v[92:95], v[136:139], v[56:59]
    v_mfma_f32_16x16x32_bf16 v[60:63], v[96:99], v[132:135], v[60:63]
    v_mfma_f32_16x16x32_bf16 v[64:67], v[96:99], v[136:139], v[64:67]
    v_mfma_f32_16x16x32_bf16 v[68:71], v[100:103], v[132:135], v[68:71]
    v_mfma_f32_16x16x32_bf16 v[72:75], v[100:103], v[136:139], v[72:75]
    s_waitcnt lgkmcnt(0)
    s_barrier
    v_mfma_f32_16x16x32_bf16 v[20:23], v[104:107], v[140:143], v[20:23]
    ds_read_b128 v[148:151], v4 offset:16384
    ds_read_b128 v[152:155], v4 offset:18432
    v_mfma_f32_16x16x32_bf16 v[24:27], v[104:107], v[144:147], v[24:27]
    ds_read_b128 v[156:159], v5 offset:16384
    ds_read_b128 v[160:163], v5 offset:18432
    v_mfma_f32_16x16x32_bf16 v[28:31], v[108:111], v[140:143], v[28:31]
    ds_read_b64_tr_b16 v[76:77], v2 offset:14336
    ds_read_b64_tr_b16 v[78:79], v2 offset:17920
    v_mfma_f32_16x16x32_bf16 v[32:35], v[108:111], v[144:147], v[32:35]
    ds_read_b64_tr_b16 v[80:81], v2 offset:14368
    ds_read_b64_tr_b16 v[82:83], v2 offset:17952
    v_mfma_f32_16x16x32_bf16 v[36:39], v[112:115], v[140:143], v[36:39]
    ds_read_b64_tr_b16 v[84:85], v2 offset:14400
    ds_read_b64_tr_b16 v[86:87], v2 offset:17984
    v_mfma_f32_16x16x32_bf16 v[40:43], v[112:115], v[144:147], v[40:43]
    ds_read_b64_tr_b16 v[88:89], v2 offset:14432
    ds_read_b64_tr_b16 v[90:91], v2 offset:18016
    v_mfma_f32_16x16x32_bf16 v[44:47], v[116:119], v[140:143], v[44:47]
    ds_read_b64_tr_b16 v[92:93], v2 offset:14464
    ds_read_b64_tr_b16 v[94:95], v2 offset:18048
    v_mfma_f32_16x16x32_bf16 v[48:51], v[116:119], v[144:147], v[48:51]
    ds_read_b64_tr_b16 v[96:97], v2 offset:14496
    ds_read_b64_tr_b16 v[98:99], v2 offset:18080
    v_mfma_f32_16x16x32_bf16 v[52:55], v[120:123], v[140:143], v[52:55]
    ds_read_b64_tr_b16 v[100:101], v2 offset:14528
    ds_read_b64_tr_b16 v[102:103], v2 offset:18112
    v_mfma_f32_16x16x32_bf16 v[56:59], v[120:123], v[144:147], v[56:59]
    v_mfma_f32_16x16x32_bf16 v[60:63], v[124:127], v[140:143], v[60:63]
    v_mfma_f32_16x16x32_bf16 v[64:67], v[124:127], v[144:147], v[64:67]
    v_mfma_f32_16x16x32_bf16 v[68:71], v[128:131], v[140:143], v[68:71]
    v_mfma_f32_16x16x32_bf16 v[72:75], v[128:131], v[144:147], v[72:75]
    s_waitcnt lgkmcnt(0)
    v_mfma_f32_16x16x32_bf16 v[20:23], v[76:79], v[148:151], v[20:23]
    ds_read_b64_tr_b16 v[104:105], v2 offset:21504
    ds_read_b64_tr_b16 v[106:107], v2 offset:25088
    v_mfma_f32_16x16x32_bf16 v[24:27], v[76:79], v[152:155], v[24:27]
    ds_read_b64_tr_b16 v[108:109], v2 offset:21536
    ds_read_b64_tr_b16 v[110:111], v2 offset:25120
    v_mfma_f32_16x16x32_bf16 v[28:31], v[80:83], v[148:151], v[28:31]
    ds_read_b64_tr_b16 v[112:113], v2 offset:21568
    ds_read_b64_tr_b16 v[114:115], v2 offset:25152
    v_mfma_f32_16x16x32_bf16 v[32:35], v[80:83], v[152:155], v[32:35]
    ds_read_b64_tr_b16 v[116:117], v2 offset:21600
    ds_read_b64_tr_b16 v[118:119], v2 offset:25184
    v_mfma_f32_16x16x32_bf16 v[36:39], v[84:87], v[148:151], v[36:39]
    ds_read_b64_tr_b16 v[120:121], v2 offset:21632
    ds_read_b64_tr_b16 v[122:123], v2 offset:25216
    v_mfma_f32_16x16x32_bf16 v[40:43], v[84:87], v[152:155], v[40:43]
    ds_read_b64_tr_b16 v[124:125], v2 offset:21664
    ds_read_b64_tr_b16 v[126:127], v2 offset:25248
    v_mfma_f32_16x16x32_bf16 v[44:47], v[88:91], v[148:151], v[44:47]
    ds_read_b64_tr_b16 v[128:129], v2 offset:21696
    ds_read_b64_tr_b16 v[130:131], v2 offset:25280
    v_mfma_f32_16x16x32_bf16 v[48:51], v[88:91], v[152:155], v[48:51]
    v_mfma_f32_16x16x32_bf16 v[52:55], v[92:95], v[148:151], v[52:55]
    v_mfma_f32_16x16x32_bf16 v[56:59], v[92:95], v[152:155], v[56:59]
    v_mfma_f32_16x16x32_bf16 v[60:63], v[96:99], v[148:151], v[60:63]
    v_mfma_f32_16x16x32_bf16 v[64:67], v[96:99], v[152:155], v[64:67]
    v_mfma_f32_16x16x32_bf16 v[68:71], v[100:103], v[148:151], v[68:71]
    v_mfma_f32_16x16x32_bf16 v[72:75], v[100:103], v[152:155], v[72:75]
    s_waitcnt lgkmcnt(0)
    s_barrier
    v_mfma_f32_16x16x32_bf16 v[20:23], v[104:107], v[156:159], v[20:23]
    ds_read_b128 v[132:135], v6 offset:0
    ds_read_b128 v[136:139], v6 offset:2048
    v_mfma_f32_16x16x32_bf16 v[24:27], v[104:107], v[160:163], v[24:27]
    ds_read_b128 v[140:143], v7 offset:0
    ds_read_b128 v[144:147], v7 offset:2048
    v_mfma_f32_16x16x32_bf16 v[28:31], v[108:111], v[156:159], v[28:31]
    ds_read_b64_tr_b16 v[76:77], v2 offset:28672
    ds_read_b64_tr_b16 v[78:79], v2 offset:32256
    v_mfma_f32_16x16x32_bf16 v[32:35], v[108:111], v[160:163], v[32:35]
    ds_read_b64_tr_b16 v[80:81], v2 offset:28704
    ds_read_b64_tr_b16 v[82:83], v2 offset:32288
    v_mfma_f32_16x16x32_bf16 v[36:39], v[112:115], v[156:159], v[36:39]
    ds_read_b64_tr_b16 v[84:85], v2 offset:28736
    ds_read_b64_tr_b16 v[86:87], v2 offset:32320
    v_mfma_f32_16x16x32_bf16 v[40:43], v[112:115], v[160:163], v[40:43]
    ds_read_b64_tr_b16 v[88:89], v2 offset:28768
    ds_read_b64_tr_b16 v[90:91], v2 offset:32352
    v_mfma_f32_16x16x32_bf16 v[44:47], v[116:119], v[156:159], v[44:47]
    ds_read_b64_tr_b16 v[92:93], v2 offset:28800
    ds_read_b64_tr_b16 v[94:95], v2 offset:32384
    v_mfma_f32_16x16x32_bf16 v[48:51], v[116:119], v[160:163], v[48:51]
    ds_read_b64_tr_b16 v[96:97], v2 offset:28832
    ds_read_b64_tr_b16 v[98:99], v2 offset:32416
    v_mfma_f32_16x16x32_bf16 v[52:55], v[120:123], v[156:159], v[52:55]
    ds_read_b64_tr_b16 v[100:101], v2 offset:28864
    ds_read_b64_tr_b16 v[102:103], v2 offset:32448
    v_mfma_f32_16x16x32_bf16 v[56:59], v[120:123], v[160:163], v[56:59]
    v_mfma_f32_16x16x32_bf16 v[60:63], v[124:127], v[156:159], v[60:63]
    v_mfma_f32_16x16x32_bf16 v[64:67], v[124:127], v[160:163], v[64:67]
    v_mfma_f32_16x16x32_bf16 v[68:71], v[128:131], v[156:159], v[68:71]
    v_mfma_f32_16x16x32_bf16 v[72:75], v[128:131], v[160:163], v[72:75]
    s_waitcnt lgkmcnt(0)
    v_mfma_f32_16x16x32_bf16 v[20:23], v[76:79], v[132:135], v[20:23]
    ds_read_b64_tr_b16 v[104:105], v2 offset:35840
    ds_read_b64_tr_b16 v[106:107], v2 offset:39424
    v_mfma_f32_16x16x32_bf16 v[24:27], v[76:79], v[136:139], v[24:27]
    ds_read_b64_tr_b16 v[108:109], v2 offset:35872
    ds_read_b64_tr_b16 v[110:111], v2 offset:39456
    v_mfma_f32_16x16x32_bf16 v[28:31], v[80:83], v[132:135], v[28:31]
    ds_read_b64_tr_b16 v[112:113], v2 offset:35904
    ds_read_b64_tr_b16 v[114:115], v2 offset:39488
    v_mfma_f32_16x16x32_bf16 v[32:35], v[80:83], v[136:139], v[32:35]
    ds_read_b64_tr_b16 v[116:117], v2 offset:35936
    ds_read_b64_tr_b16 v[118:119], v2 offset:39520
    v_mfma_f32_16x16x32_bf16 v[36:39], v[84:87], v[132:135], v[36:39]
    ds_read_b64_tr_b16 v[120:121], v2 offset:35968
    ds_read_b64_tr_b16 v[122:123], v2 offset:39552
    v_mfma_f32_16x16x32_bf16 v[40:43], v[84:87], v[136:139], v[40:43]
    ds_read_b64_tr_b16 v[124:125], v2 offset:36000
    ds_read_b64_tr_b16 v[126:127], v2 offset:39584
    v_mfma_f32_16x16x32_bf16 v[44:47], v[88:91], v[132:135], v[44:47]
    ds_read_b64_tr_b16 v[128:129], v2 offset:36032
    ds_read_b64_tr_b16 v[130:131], v2 offset:39616
    v_mfma_f32_16x16x32_bf16 v[48:51], v[88:91], v[136:139], v[48:51]
    v_mfma_f32_16x16x32_bf16 v[52:55], v[92:95], v[132:135], v[52:55]
    v_mfma_f32_16x16x32_bf16 v[56:59], v[92:95], v[136:139], v[56:59]
    v_mfma_f32_16x16x32_bf16 v[60:63], v[96:99], v[132:135], v[60:63]
    v_mfma_f32_16x16x32_bf16 v[64:67], v[96:99], v[136:139], v[64:67]
    v_mfma_f32_16x16x32_bf16 v[68:71], v[100:103], v[132:135], v[68:71]
    v_mfma_f32_16x16x32_bf16 v[72:75], v[100:103], v[136:139], v[72:75]
    s_waitcnt lgkmcnt(0)
    s_barrier
    v_mfma_f32_16x16x32_bf16 v[20:23], v[104:107], v[140:143], v[20:23]
    ds_read_b128 v[148:151], v4 offset:0
    ds_read_b128 v[152:155], v4 offset:2048
    v_mfma_f32_16x16x32_bf16 v[24:27], v[104:107], v[144:147], v[24:27]
    ds_read_b128 v[156:159], v5 offset:0
    ds_read_b128 v[160:163], v5 offset:2048
    v_mfma_f32_16x16x32_bf16 v[28:31], v[108:111], v[140:143], v[28:31]
    ds_read_b64_tr_b16 v[76:77], v2 offset:43008
    ds_read_b64_tr_b16 v[78:79], v2 offset:46592
    v_mfma_f32_16x16x32_bf16 v[32:35], v[108:111], v[144:147], v[32:35]
    ds_read_b64_tr_b16 v[80:81], v2 offset:43040
    ds_read_b64_tr_b16 v[82:83], v2 offset:46624
    v_mfma_f32_16x16x32_bf16 v[36:39], v[112:115], v[140:143], v[36:39]
    ds_read_b64_tr_b16 v[84:85], v2 offset:43072
    ds_read_b64_tr_b16 v[86:87], v2 offset:46656
    v_mfma_f32_16x16x32_bf16 v[40:43], v[112:115], v[144:147], v[40:43]
    ds_read_b64_tr_b16 v[88:89], v2 offset:43104
    ds_read_b64_tr_b16 v[90:91], v2 offset:46688
    v_mfma_f32_16x16x32_bf16 v[44:47], v[116:119], v[140:143], v[44:47]
    ds_read_b64_tr_b16 v[92:93], v2 offset:43136
    ds_read_b64_tr_b16 v[94:95], v2 offset:46720
    v_mfma_f32_16x16x32_bf16 v[48:51], v[116:119], v[144:147], v[48:51]
    ds_read_b64_tr_b16 v[96:97], v2 offset:43168
    ds_read_b64_tr_b16 v[98:99], v2 offset:46752
    v_mfma_f32_16x16x32_bf16 v[52:55], v[120:123], v[140:143], v[52:55]
    ds_read_b64_tr_b16 v[100:101], v2 offset:43200
    ds_read_b64_tr_b16 v[102:103], v2 offset:46784
    v_mfma_f32_16x16x32_bf16 v[56:59], v[120:123], v[144:147], v[56:59]
    v_mfma_f32_16x16x32_bf16 v[60:63], v[124:127], v[140:143], v[60:63]
    v_mfma_f32_16x16x32_bf16 v[64:67], v[124:127], v[144:147], v[64:67]
    v_mfma_f32_16x16x32_bf16 v[68:71], v[128:131], v[140:143], v[68:71]
    v_mfma_f32_16x16x32_bf16 v[72:75], v[128:131], v[144:147], v[72:75]
    s_waitcnt lgkmcnt(0)
    v_mfma_f32_16x16x32_bf16 v[20:23], v[76:79], v[148:151], v[20:23]
    ds_read_b64_tr_b16 v[104:105], v2 offset:50176
    ds_read_b64_tr_b16 v[106:107], v2 offset:53760
    v_mfma_f32_16x16x32_bf16 v[24:27], v[76:79], v[152:155], v[24:27]
    ds_read_b64_tr_b16 v[108:109], v2 offset:50208
    ds_read_b64_tr_b16 v[110:111], v2 offset:53792
    v_mfma_f32_16x16x32_bf16 v[28:31], v[80:83], v[148:151], v[28:31]
    ds_read_b64_tr_b16 v[112:113], v2 offset:50240
    ds_read_b64_tr_b16 v[114:115], v2 offset:53824
    v_mfma_f32_16x16x32_bf16 v[32:35], v[80:83], v[152:155], v[32:35]
    ds_read_b64_tr_b16 v[116:117], v2 offset:50272
    ds_read_b64_tr_b16 v[118:119], v2 offset:53856
    v_mfma_f32_16x16x32_bf16 v[36:39], v[84:87], v[148:151], v[36:39]
    ds_read_b64_tr_b16 v[120:121], v2 offset:50304
    ds_read_b64_tr_b16 v[122:123], v2 offset:53888
    v_mfma_f32_16x16x32_bf16 v[40:43], v[84:87], v[152:155], v[40:43]
    ds_read_b64_tr_b16 v[124:125], v2 offset:50336
    ds_read_b64_tr_b16 v[126:127], v2 offset:53920
    v_mfma_f32_16x16x32_bf16 v[44:47], v[88:91], v[148:151], v[44:47]
    ds_read_b64_tr_b16 v[128:129], v2 offset:50368
    ds_read_b64_tr_b16 v[130:131], v2 offset:53952
    v_mfma_f32_16x16x32_bf16 v[48:51], v[88:91], v[152:155], v[48:51]
    v_mfma_f32_16x16x32_bf16 v[52:55], v[92:95], v[148:151], v[52:55]
    v_mfma_f32_16x16x32_bf16 v[56:59], v[92:95], v[152:155], v[56:59]
    v_mfma_f32_16x16x32_bf16 v[60:63], v[96:99], v[148:151], v[60:63]
    v_mfma_f32_16x16x32_bf16 v[64:67], v[96:99], v[152:155], v[64:67]
    v_mfma_f32_16x16x32_bf16 v[68:71], v[100:103], v[148:151], v[68:71]
    v_mfma_f32_16x16x32_bf16 v[72:75], v[100:103], v[152:155], v[72:75]
    s_waitcnt lgkmcnt(0)
    s_barrier
    v_mfma_f32_16x16x32_bf16 v[20:23], v[104:107], v[156:159], v[20:23]
    ds_read_b128 v[132:135], v4 offset:16384
    ds_read_b128 v[136:139], v4 offset:18432
    v_mfma_f32_16x16x32_bf16 v[24:27], v[104:107], v[160:163], v[24:27]
    ds_read_b128 v[140:143], v5 offset:16384
    ds_read_b128 v[144:147], v5 offset:18432
    v_mfma_f32_16x16x32_bf16 v[28:31], v[108:111], v[156:159], v[28:31]
    ds_read_b64_tr_b16 v[76:77], v3 offset:0
    ds_read_b64_tr_b16 v[78:79], v3 offset:3584
    v_mfma_f32_16x16x32_bf16 v[32:35], v[108:111], v[160:163], v[32:35]
    ds_read_b64_tr_b16 v[80:81], v3 offset:32
    ds_read_b64_tr_b16 v[82:83], v3 offset:3616
    v_mfma_f32_16x16x32_bf16 v[36:39], v[112:115], v[156:159], v[36:39]
    ds_read_b64_tr_b16 v[84:85], v3 offset:64
    ds_read_b64_tr_b16 v[86:87], v3 offset:3648
    v_mfma_f32_16x16x32_bf16 v[40:43], v[112:115], v[160:163], v[40:43]
    ds_read_b64_tr_b16 v[88:89], v3 offset:96
    ds_read_b64_tr_b16 v[90:91], v3 offset:3680
    v_mfma_f32_16x16x32_bf16 v[44:47], v[116:119], v[156:159], v[44:47]
    ds_read_b64_tr_b16 v[92:93], v3 offset:128
    ds_read_b64_tr_b16 v[94:95], v3 offset:3712
    v_mfma_f32_16x16x32_bf16 v[48:51], v[116:119], v[160:163], v[48:51]
    ds_read_b64_tr_b16 v[96:97], v3 offset:160
    ds_read_b64_tr_b16 v[98:99], v3 offset:3744
    v_mfma_f32_16x16x32_bf16 v[52:55], v[120:123], v[156:159], v[52:55]
    ds_read_b64_tr_b16 v[100:101], v3 offset:192
    ds_read_b64_tr_b16 v[102:103], v3 offset:3776
    v_mfma_f32_16x16x32_bf16 v[56:59], v[120:123], v[160:163], v[56:59]
    v_mfma_f32_16x16x32_bf16 v[60:63], v[124:127], v[156:159], v[60:63]
    v_mfma_f32_16x16x32_bf16 v[64:67], v[124:127], v[160:163], v[64:67]
    v_mfma_f32_16x16x32_bf16 v[68:71], v[128:131], v[156:159], v[68:71]
    v_mfma_f32_16x16x32_bf16 v[72:75], v[128:131], v[160:163], v[72:75]
    s_waitcnt lgkmcnt(0)
    buffer_load_dword v247, v246, s[48:51], 0 offen sc1
    v_mfma_f32_16x16x32_bf16 v[20:23], v[76:79], v[132:135], v[20:23]
    ds_read_b64_tr_b16 v[104:105], v3 offset:7168
    ds_read_b64_tr_b16 v[106:107], v3 offset:10752
    v_mfma_f32_16x16x32_bf16 v[24:27], v[76:79], v[136:139], v[24:27]
    ds_read_b64_tr_b16 v[108:109], v3 offset:7200
    ds_read_b64_tr_b16 v[110:111], v3 offset:10784
    v_mfma_f32_16x16x32_bf16 v[28:31], v[80:83], v[132:135], v[28:31]
    ds_read_b64_tr_b16 v[112:113], v3 offset:7232
    ds_read_b64_tr_b16 v[114:115], v3 offset:10816
    v_mfma_f32_16x16x32_bf16 v[32:35], v[80:83], v[136:139], v[32:35]
    ds_read_b64_tr_b16 v[116:117], v3 offset:7264
    ds_read_b64_tr_b16 v[118:119], v3 offset:10848
    v_mfma_f32_16x16x32_bf16 v[36:39], v[84:87], v[132:135], v[36:39]
    ds_read_b64_tr_b16 v[120:121], v3 offset:7296
    ds_read_b64_tr_b16 v[122:123], v3 offset:10880
    v_mfma_f32_16x16x32_bf16 v[40:43], v[84:87], v[136:139], v[40:43]
    ds_read_b64_tr_b16 v[124:125], v3 offset:7328
    ds_read_b64_tr_b16 v[126:127], v3 offset:10912
    v_mfma_f32_16x16x32_bf16 v[44:47], v[88:91], v[132:135], v[44:47]
    ds_read_b64_tr_b16 v[128:129], v3 offset:7360
    ds_read_b64_tr_b16 v[130:131], v3 offset:10944
    v_mfma_f32_16x16x32_bf16 v[48:51], v[88:91], v[136:139], v[48:51]
    v_mfma_f32_16x16x32_bf16 v[52:55], v[92:95], v[132:135], v[52:55]
    v_mfma_f32_16x16x32_bf16 v[56:59], v[92:95], v[136:139], v[56:59]
    v_mfma_f32_16x16x32_bf16 v[60:63], v[96:99], v[132:135], v[60:63]
    v_mfma_f32_16x16x32_bf16 v[64:67], v[96:99], v[136:139], v[64:67]
    v_mfma_f32_16x16x32_bf16 v[68:71], v[100:103], v[132:135], v[68:71]
    v_mfma_f32_16x16x32_bf16 v[72:75], v[100:103], v[136:139], v[72:75]
    s_waitcnt lgkmcnt(0)
    s_barrier
    v_mfma_f32_16x16x32_bf16 v[20:23], v[104:107], v[140:143], v[20:23]
    ds_read_b128 v[148:151], v6 offset:0
    ds_read_b128 v[152:155], v6 offset:2048
    v_mfma_f32_16x16x32_bf16 v[24:27], v[104:107], v[144:147], v[24:27]
    ds_read_b128 v[156:159], v7 offset:0
    ds_read_b128 v[160:163], v7 offset:2048
    v_mfma_f32_16x16x32_bf16 v[28:31], v[108:111], v[140:143], v[28:31]
    ds_read_b64_tr_b16 v[76:77], v2 offset:0
    ds_read_b64_tr_b16 v[78:79], v2 offset:3584
    v_mfma_f32_16x16x32_bf16 v[32:35], v[108:111], v[144:147], v[32:35]
    ds_read_b64_tr_b16 v[80:81], v2 offset:32
    ds_read_b64_tr_b16 v[82:83], v2 offset:3616
    v_mfma_f32_16x16x32_bf16 v[36:39], v[112:115], v[140:143], v[36:39]
    ds_read_b64_tr_b16 v[84:85], v2 offset:64
    ds_read_b64_tr_b16 v[86:87], v2 offset:3648
    v_mfma_f32_16x16x32_bf16 v[40:43], v[112:115], v[144:147], v[40:43]
    ds_read_b64_tr_b16 v[88:89], v2 offset:96
    ds_read_b64_tr_b16 v[90:91], v2 offset:3680
    v_mfma_f32_16x16x32_bf16 v[44:47], v[116:119], v[140:143], v[44:47]
    ds_read_b64_tr_b16 v[92:93], v2 offset:128
    ds_read_b64_tr_b16 v[94:95], v2 offset:3712
    v_mfma_f32_16x16x32_bf16 v[48:51], v[116:119], v[144:147], v[48:51]
    ds_read_b64_tr_b16 v[96:97], v2 offset:160
    ds_read_b64_tr_b16 v[98:99], v2 offset:3744
    v_mfma_f32_16x16x32_bf16 v[52:55], v[120:123], v[140:143], v[52:55]
    ds_read_b64_tr_b16 v[100:101], v2 offset:192
    ds_read_b64_tr_b16 v[102:103], v2 offset:3776
    v_mfma_f32_16x16x32_bf16 v[56:59], v[120:123], v[144:147], v[56:59]
    v_mfma_f32_16x16x32_bf16 v[60:63], v[124:127], v[140:143], v[60:63]
    v_mfma_f32_16x16x32_bf16 v[64:67], v[124:127], v[144:147], v[64:67]
    v_mfma_f32_16x16x32_bf16 v[68:71], v[128:131], v[140:143], v[68:71]
    v_mfma_f32_16x16x32_bf16 v[72:75], v[128:131], v[144:147], v[72:75]
    s_waitcnt lgkmcnt(0)
    s_mov_b32 s60, s28
    s_mov_b32 s61, s29
    s_mov_b32 s62, 1835008
    s_mov_b32 s63, 0x20000
    s_lshr_b32 s92, s2, 3
    s_lshl_b32 s92, s92, 2
    s_add_u32 s92, s92, s84
    s_mul_i32 s92, s92, 112
    v_add_u32 v18, s92, v1
    v_lshlrev_b32 v18, 7, v18
    s_mov_b32 exec_hi, 0x00ffffff
    buffer_load_dword v248, v18, s[60:63], 0 offen
    v_add_u32 v18, 7168, v18
    buffer_load_dword v249, v18, s[60:63], 0 offen
    s_mov_b32 exec_hi, -1
    v_mfma_f32_16x16x32_bf16 v[20:23], v[76:79], v[148:151], v[20:23]
    ds_read_b64_tr_b16 v[104:105], v2 offset:7168
    ds_read_b64_tr_b16 v[106:107], v2 offset:10752
    v_mfma_f32_16x16x32_bf16 v[24:27], v[76:79], v[152:155], v[24:27]
    ds_read_b64_tr_b16 v[108:109], v2 offset:7200
    ds_read_b64_tr_b16 v[110:111], v2 offset:10784
    v_mfma_f32_16x16x32_bf16 v[28:31], v[80:83], v[148:151], v[28:31]
    ds_read_b64_tr_b16 v[112:113], v2 offset:7232
    ds_read_b64_tr_b16 v[114:115], v2 offset:10816
    v_mfma_f32_16x16x32_bf16 v[32:35], v[80:83], v[152:155], v[32:35]
    ds_read_b64_tr_b16 v[116:117], v2 offset:7264
    ds_read_b64_tr_b16 v[118:119], v2 offset:10848
    v_mfma_f32_16x16x32_bf16 v[36:39], v[84:87], v[148:151], v[36:39]
    ds_read_b64_tr_b16 v[120:121], v2 offset:7296
    ds_read_b64_tr_b16 v[122:123], v2 offset:10880
    v_mfma_f32_16x16x32_bf16 v[40:43], v[84:87], v[152:155], v[40:43]
    ds_read_b64_tr_b16 v[124:125], v2 offset:7328
    ds_read_b64_tr_b16 v[126:127], v2 offset:10912
    v_mfma_f32_16x16x32_bf16 v[44:47], v[88:91], v[148:151], v[44:47]
    ds_read_b64_tr_b16 v[128:129], v2 offset:7360
    ds_read_b64_tr_b16 v[130:131], v2 offset:10944
    v_mfma_f32_16x16x32_bf16 v[48:51], v[88:91], v[152:155], v[48:51]
    v_mfma_f32_16x16x32_bf16 v[52:55], v[92:95], v[148:151], v[52:55]
    v_mfma_f32_16x16x32_bf16 v[56:59], v[92:95], v[152:155], v[56:59]
    v_mfma_f32_16x16x32_bf16 v[60:63], v[96:99], v[148:151], v[60:63]
    v_mfma_f32_16x16x32_bf16 v[64:67], v[96:99], v[152:155], v[64:67]
    v_mfma_f32_16x16x32_bf16 v[68:71], v[100:103], v[148:151], v[68:71]
    v_mfma_f32_16x16x32_bf16 v[72:75], v[100:103], v[152:155], v[72:75]
    s_waitcnt lgkmcnt(0)
    s_barrier
    v_mfma_f32_16x16x32_bf16 v[20:23], v[104:107], v[156:159], v[20:23]
    ds_read_b128 v[132:135], v4 offset:0
    ds_read_b128 v[136:139], v4 offset:2048
    v_mfma_f32_16x16x32_bf16 v[24:27], v[104:107], v[160:163], v[24:27]
    ds_read_b128 v[140:143], v5 offset:0
    ds_read_b128 v[144:147], v5 offset:2048
    v_mfma_f32_16x16x32_bf16 v[28:31], v[108:111], v[156:159], v[28:31]
    ds_read_b64_tr_b16 v[76:77], v2 offset:14336
    ds_read_b64_tr_b16 v[78:79], v2 offset:17920
    v_mfma_f32_16x16x32_bf16 v[32:35], v[108:111], v[160:163], v[32:35]
    ds_read_b64_tr_b16 v[80:81], v2 offset:14368
    ds_read_b64_tr_b16 v[82:83], v2 offset:17952
    v_mfma_f32_16x16x32_bf16 v[36:39], v[112:115], v[156:159], v[36:39]
    ds_read_b64_tr_b16 v[84:85], v2 offset:14400
    ds_read_b64_tr_b16 v[86:87], v2 offset:17984
    v_mfma_f32_16x16x32_bf16 v[40:43], v[112:115], v[160:163], v[40:43]
    ds_read_b64_tr_b16 v[88:89], v2 offset:14432
    ds_read_b64_tr_b16 v[90:91], v2 offset:18016
    v_mfma_f32_16x16x32_bf16 v[44:47], v[116:119], v[156:159], v[44:47]
    ds_read_b64_tr_b16 v[92:93], v2 offset:14464
    ds_read_b64_tr_b16 v[94:95], v2 offset:18048
    v_mfma_f32_16x16x32_bf16 v[48:51], v[116:119], v[160:163], v[48:51]
    ds_read_b64_tr_b16 v[96:97], v2 offset:14496
    ds_read_b64_tr_b16 v[98:99], v2 offset:18080
    v_mfma_f32_16x16x32_bf16 v[52:55], v[120:123], v[156:159], v[52:55]
    ds_read_b64_tr_b16 v[100:101], v2 offset:14528
    ds_read_b64_tr_b16 v[102:103], v2 offset:18112
    v_mfma_f32_16x16x32_bf16 v[56:59], v[120:123], v[160:163], v[56:59]
    v_mfma_f32_16x16x32_bf16 v[60:63], v[124:127], v[156:159], v[60:63]
    v_mfma_f32_16x16x32_bf16 v[64:67], v[124:127], v[160:163], v[64:67]
    v_mfma_f32_16x16x32_bf16 v[68:71], v[128:131], v[156:159], v[68:71]
    v_mfma_f32_16x16x32_bf16 v[72:75], v[128:131], v[160:163], v[72:75]
    s_waitcnt lgkmcnt(0)
    v_mfma_f32_16x16x32_bf16 v[20:23], v[76:79], v[132:135], v[20:23]
    ds_read_b64_tr_b16 v[104:105], v2 offset:21504
    ds_read_b64_tr_b16 v[106:107], v2 offset:25088
    v_mfma_f32_16x16x32_bf16 v[24:27], v[76:79], v[136:139], v[24:27]
    ds_read_b64_tr_b16 v[108:109], v2 offset:21536
    ds_read_b64_tr_b16 v[110:111], v2 offset:25120
    v_mfma_f32_16x16x32_bf16 v[28:31], v[80:83], v[132:135], v[28:31]
    ds_read_b64_tr_b16 v[112:113], v2 offset:21568
    ds_read_b64_tr_b16 v[114:115], v2 offset:25152
    v_mfma_f32_16x16x32_bf16 v[32:35], v[80:83], v[136:139], v[32:35]
    ds_read_b64_tr_b16 v[116:117], v2 offset:21600
    ds_read_b64_tr_b16 v[118:119], v2 offset:25184
    v_mfma_f32_16x16x32_bf16 v[36:39], v[84:87], v[132:135], v[36:39]
    ds_read_b64_tr_b16 v[120:121], v2 offset:21632
    ds_read_b64_tr_b16 v[122:123], v2 offset:25216
    v_mfma_f32_16x16x32_bf16 v[40:43], v[84:87], v[136:139], v[40:43]
    ds_read_b64_tr_b16 v[124:125], v2 offset:21664
    ds_read_b64_tr_b16 v[126:127], v2 offset:25248
    v_mfma_f32_16x16x32_bf16 v[44:47], v[88:91], v[132:135], v[44:47]
    ds_read_b64_tr_b16 v[128:129], v2 offset:21696
    ds_read_b64_tr_b16 v[130:131], v2 offset:25280
    v_mfma_f32_16x16x32_bf16 v[48:51], v[88:91], v[136:139], v[48:51]
    v_mfma_f32_16x16x32_bf16 v[52:55], v[92:95], v[132:135], v[52:55]
    v_mfma_f32_16x16x32_bf16 v[56:59], v[92:95], v[136:139], v[56:59]
    v_mfma_f32_16x16x32_bf16 v[60:63], v[96:99], v[132:135], v[60:63]
    v_mfma_f32_16x16x32_bf16 v[64:67], v[96:99], v[136:139], v[64:67]
    v_mfma_f32_16x16x32_bf16 v[68:71], v[100:103], v[132:135], v[68:71]
    v_mfma_f32_16x16x32_bf16 v[72:75], v[100:103], v[136:139], v[72:75]
    s_waitcnt lgkmcnt(0)
    s_barrier
    v_mfma_f32_16x16x32_bf16 v[20:23], v[104:107], v[140:143], v[20:23]
    ds_read_b128 v[148:151], v4 offset:16384
    ds_read_b128 v[152:155], v4 offset:18432
    v_mfma_f32_16x16x32_bf16 v[24:27], v[104:107], v[144:147], v[24:27]
    ds_read_b128 v[156:159], v5 offset:16384
    ds_read_b128 v[160:163], v5 offset:18432
    v_mfma_f32_16x16x32_bf16 v[28:31], v[108:111], v[140:143], v[28:31]
    ds_read_b64_tr_b16 v[76:77], v2 offset:28672
    ds_read_b64_tr_b16 v[78:79], v2 offset:32256
    v_mfma_f32_16x16x32_bf16 v[32:35], v[108:111], v[144:147], v[32:35]
    ds_read_b64_tr_b16 v[80:81], v2 offset:28704
    ds_read_b64_tr_b16 v[82:83], v2 offset:32288
    v_mfma_f32_16x16x32_bf16 v[36:39], v[112:115], v[140:143], v[36:39]
    ds_read_b64_tr_b16 v[84:85], v2 offset:28736
    ds_read_b64_tr_b16 v[86:87], v2 offset:32320
    v_mfma_f32_16x16x32_bf16 v[40:43], v[112:115], v[144:147], v[40:43]
    ds_read_b64_tr_b16 v[88:89], v2 offset:28768
    ds_read_b64_tr_b16 v[90:91], v2 offset:32352
    v_mfma_f32_16x16x32_bf16 v[44:47], v[116:119], v[140:143], v[44:47]
    ds_read_b64_tr_b16 v[92:93], v2 offset:28800
    ds_read_b64_tr_b16 v[94:95], v2 offset:32384
    v_mfma_f32_16x16x32_bf16 v[48:51], v[116:119], v[144:147], v[48:51]
    ds_read_b64_tr_b16 v[96:97], v2 offset:28832
    ds_read_b64_tr_b16 v[98:99], v2 offset:32416
    v_mfma_f32_16x16x32_bf16 v[52:55], v[120:123], v[140:143], v[52:55]
    ds_read_b64_tr_b16 v[100:101], v2 offset:28864
    ds_read_b64_tr_b16 v[102:103], v2 offset:32448
    v_mfma_f32_16x16x32_bf16 v[56:59], v[120:123], v[144:147], v[56:59]
    v_mfma_f32_16x16x32_bf16 v[60:63], v[124:127], v[140:143], v[60:63]
    v_mfma_f32_16x16x32_bf16 v[64:67], v[124:127], v[144:147], v[64:67]
    v_mfma_f32_16x16x32_bf16 v[68:71], v[128:131], v[140:143], v[68:71]
    v_mfma_f32_16x16x32_bf16 v[72:75], v[128:131], v[144:147], v[72:75]
    s_waitcnt lgkmcnt(0)
    s_waitcnt vmcnt(2)
    s_mov_b32 s53, 100000
rchk_11:
    v_subrev_u32 v247, s90, v247
    v_cmp_le_u32 vcc, 16, v247
    s_cmp_eq_u64 vcc, 0
    s_cbranch_scc1 rchkd_12
    s_sleep 1
    buffer_load_dword v247, v246, s[48:51], 0 offen sc1
    s_waitcnt vmcnt(0)
    s_sub_u32 s53, s53, 1
    s_cmp_lg_u32 s53, 0
    s_cbranch_scc1 rchk_11
    v_subrev_u32 v247, s90, v247
rchkd_12:
    s_getreg_b32 s92, hwreg(HW_REG_XCC_ID, 0, 4)
    s_nop 0
    v_cmp_ne_u32 vcc, s92, v247
    s_cmp_eq_u64 vcc, 0
    s_cselect_b32 s91, 1, 0
    v_mfma_f32_16x16x32_bf16 v[20:23], v[76:79], v[148:151], v[20:23]
    ds_read_b64_tr_b16 v[104:105], v2 offset:35840
    ds_read_b64_tr_b16 v[106:107], v2 offset:39424
    v_mfma_f32_16x16x32_bf16 v[24:27], v[76:79], v[152:155], v[24:27]
    ds_read_b64_tr_b16 v[108:109], v2 offset:35872
    ds_read_b64_tr_b16 v[110:111], v2 offset:39456
    v_mfma_f32_16x16x32_bf16 v[28:31], v[80:83], v[148:151], v[28:31]
    ds_read_b64_tr_b16 v[112:113], v2 offset:35904
    ds_read_b64_tr_b16 v[114:115], v2 offset:39488
    v_mfma_f32_16x16x32_bf16 v[32:35], v[80:83], v[152:155], v[32:35]
    ds_read_b64_tr_b16 v[116:117], v2 offset:35936
    ds_read_b64_tr_b16 v[118:119], v2 offset:39520
    v_mfma_f32_16x16x32_bf16 v[36:39], v[84:87], v[148:151], v[36:39]
    ds_read_b64_tr_b16 v[120:121], v2 offset:35968
    ds_read_b64_tr_b16 v[122:123], v2 offset:39552
    v_mfma_f32_16x16x32_bf16 v[40:43], v[84:87], v[152:155], v[40:43]
    ds_read_b64_tr_b16 v[124:125], v2 offset:36000
    ds_read_b64_tr_b16 v[126:127], v2 offset:39584
    v_mfma_f32_16x16x32_bf16 v[44:47], v[88:91], v[148:151], v[44:47]
    ds_read_b64_tr_b16 v[128:129], v2 offset:36032
    ds_read_b64_tr_b16 v[130:131], v2 offset:39616
    v_mfma_f32_16x16x32_bf16 v[48:51], v[88:91], v[152:155], v[48:51]
    v_mfma_f32_16x16x32_bf16 v[52:55], v[92:95], v[148:151], v[52:55]
    v_mfma_f32_16x16x32_bf16 v[56:59], v[92:95], v[152:155], v[56:59]
    v_mfma_f32_16x16x32_bf16 v[60:63], v[96:99], v[148:151], v[60:63]
    v_mfma_f32_16x16x32_bf16 v[64:67], v[96:99], v[152:155], v[64:67]
    v_mfma_f32_16x16x32_bf16 v[68:71], v[100:103], v[148:151], v[68:71]
    v_mfma_f32_16x16x32_bf16 v[72:75], v[100:103], v[152:155], v[72:75]
    s_waitcnt lgkmcnt(0)
    s_barrier
    v_mfma_f32_16x16x32_bf16 v[20:23], v[104:107], v[156:159], v[20:23]
    v_mfma_f32_16x16x32_bf16 v[24:27], v[104:107], v[160:163], v[24:27]
    v_mfma_f32_16x16x32_bf16 v[28:31], v[108:111], v[156:159], v[28:31]
    v_mfma_f32_16x16x32_bf16 v[32:35], v[108:111], v[160:163], v[32:35]
    v_mfma_f32_16x16x32_bf16 v[36:39], v[112:115], v[156:159], v[36:39]
    v_mfma_f32_16x16x32_bf16 v[40:43], v[112:115], v[160:163], v[40:43]
    v_mfma_f32_16x16x32_bf16 v[44:47], v[116:119], v[156:159], v[44:47]
    v_mfma_f32_16x16x32_bf16 v[48:51], v[116:119], v[160:163], v[48:51]
    v_mfma_f32_16x16x32_bf16 v[52:55], v[120:123], v[156:159], v[52:55]
    v_mfma_f32_16x16x32_bf16 v[56:59], v[120:123], v[160:163], v[56:59]
    v_mfma_f32_16x16x32_bf16 v[60:63], v[124:127], v[156:159], v[60:63]
    v_mfma_f32_16x16x32_bf16 v[64:67], v[124:127], v[160:163], v[64:67]
    v_mfma_f32_16x16x32_bf16 v[68:71], v[128:131], v[156:159], v[68:71]
    v_mfma_f32_16x16x32_bf16 v[72:75], v[128:131], v[160:163], v[72:75]
    s_lshl_b32 s92, s86, 3
    s_lshl_b32 s93, s84, 1
    s_add_u32 s92, s92, s93
    s_lshl_b32 s92, s92, 4
    s_add_u32 s92, s92, s87
    s_mul_i32 s92, s92, 3584
    v_lshlrev_b32 v12, 4, v1
    v_add_u32 v12, s92, v12
    v_lshlrev_b32 v13, 3, v1
    v_add_u32 v13, s92, v13
    s_mov_b32 s93, 57344
    v_mul_f32_e64 v20, v20, |v20|
    v_mul_f32_e64 v21, v21, |v21|
    v_mul_f32_e64 v22, v22, |v22|
    v_mul_f32_e64 v23, v23, |v23|
    v_mul_f32_e64 v28, v28, |v28|
    v_mul_f32_e64 v29, v29, |v29|
    v_mul_f32_e64 v30, v30, |v30|
    v_mul_f32_e64 v31, v31, |v31|
    v_cvt_pk_bf16_f32 v20, v20, v21
    v_cvt_pk_bf16_f32 v21, v22, v23
    v_cvt_pk_bf16_f32 v22, v28, v29
    v_cvt_pk_bf16_f32 v23, v30, v31
    v_pk_max_i16 v20, v20, 0
    v_pk_max_i16 v21, v21, 0
    v_pk_max_i16 v22, v22, 0
    v_pk_max_i16 v23, v23, 0
    buffer_store_dwordx4 v[20:23], v12, s[56:59], 0 offen offset:0
    v_mul_f32_e64 v36, v36, |v36|
    v_mul_f32_e64 v37, v37, |v37|
    v_mul_f32_e64 v38, v38, |v38|
    v_mul_f32_e64 v39, v39, |v39|
    v_mul_f32_e64 v44, v44, |v44|
    v_mul_f32_e64 v45, v45, |v45|
    v_mul_f32_e64 v46, v46, |v46|
    v_mul_f32_e64 v47, v47, |v47|
    v_cvt_pk_bf16_f32 v36, v36, v37
    v_cvt_pk_bf16_f32 v37, v38, v39
    v_cvt_pk_bf16_f32 v38, v44, v45
    v_cvt_pk_bf16_f32 v39, v46, v47
    v_pk_max_i16 v36, v36, 0
    v_pk_max_i16 v37, v37, 0
    v_pk_max_i16 v38, v38, 0
    v_pk_max_i16 v39, v39, 0
    buffer_store_dwordx4 v[36:39], v12, s[56:59], 0 offen offset:1024
    v_mul_f32_e64 v52, v52, |v52|
    v_mul_f32_e64 v53, v53, |v53|
    v_mul_f32_e64 v54, v54, |v54|
    v_mul_f32_e64 v55, v55, |v55|
    v_mul_f32_e64 v60, v60, |v60|
    v_mul_f32_e64 v61, v61, |v61|
    v_mul_f32_e64 v62, v62, |v62|
    v_mul_f32_e64 v63, v63, |v63|
    v_cvt_pk_bf16_f32 v52, v52, v53
    v_cvt_pk_bf16_f32 v53, v54, v55
    v_cvt_pk_bf16_f32 v54, v60, v61
    v_cvt_pk_bf16_f32 v55, v62, v63
    v_pk_max_i16 v52, v52, 0
    v_pk_max_i16 v53, v53, 0
    v_pk_max_i16 v54, v54, 0
    v_pk_max_i16 v55, v55, 0
    buffer_store_dwordx4 v[52:55], v12, s[56:59], 0 offen offset:2048
    v_mul_f32_e64 v68, v68, |v68|
    v_mul_f32_e64 v69, v69, |v69|
    v_mul_f32_e64 v70, v70, |v70|
    v_mul_f32_e64 v71, v71, |v71|
    v_cvt_pk_bf16_f32 v68, v68, v69
    v_cvt_pk_bf16_f32 v69, v70, v71
    v_pk_max_i16 v68, v68, 0
    v_pk_max_i16 v69, v69, 0
    buffer_store_dwordx2 v[68:69], v13, s[56:59], 0 offen offset:3072
    v_mul_f32_e64 v24, v24, |v24|
    v_mul_f32_e64 v25, v25, |v25|
    v_mul_f32_e64 v26, v26, |v26|
    v_mul_f32_e64 v27, v27, |v27|
    v_mul_f32_e64 v32, v32, |v32|
    v_mul_f32_e64 v33, v33, |v33|
    v_mul_f32_e64 v34, v34, |v34|
    v_mul_f32_e64 v35, v35, |v35|
    v_cvt_pk_bf16_f32 v24, v24, v25
    v_cvt_pk_bf16_f32 v25, v26, v27
    v_cvt_pk_bf16_f32 v26, v32, v33
    v_cvt_pk_bf16_f32 v27, v34, v35
    v_pk_max_i16 v24, v24, 0
    v_pk_max_i16 v25, v25, 0
    v_pk_max_i16 v26, v26, 0
    v_pk_max_i16 v27, v27, 0
    buffer_store_dwordx4 v[24:27], v12, s[56:59], s93 offen offset:0
    v_mul_f32_e64 v40, v40, |v40|
    v_mul_f32_e64 v41, v41, |v41|
    v_mul_f32_e64 v42, v42, |v42|
    v_mul_f32_e64 v43, v43, |v43|
    v_mul_f32_e64 v48, v48, |v48|
    v_mul_f32_e64 v49, v49, |v49|
    v_mul_f32_e64 v50, v50, |v50|
    v_mul_f32_e64 v51, v51, |v51|
    v_cvt_pk_bf16_f32 v40, v40, v41
    v_cvt_pk_bf16_f32 v41, v42, v43
    v_cvt_pk_bf16_f32 v42, v48, v49
    v_cvt_pk_bf16_f32 v43, v50, v51
    v_pk_max_i16 v40, v40, 0
    v_pk_max_i16 v41, v41, 0
    v_pk_max_i16 v42, v42, 0
    v_pk_max_i16 v43, v43, 0
    buffer_store_dwordx4 v[40:43], v12, s[56:59], s93 offen offset:1024
    v_mul_f32_e64 v56, v56, |v56|
    v_mul_f32_e64 v57, v57, |v57|
    v_mul_f32_e64 v58, v58, |v58|
    v_mul_f32_e64 v59, v59, |v59|
    v_mul_f32_e64 v64, v64, |v64|
    v_mul_f32_e64 v65, v65, |v65|
    v_mul_f32_e64 v66, v66, |v66|
    v_mul_f32_e64 v67, v67, |v67|
    v_cvt_pk_bf16_f32 v56, v56, v57
    v_cvt_pk_bf16_f32 v57, v58, v59
    v_cvt_pk_bf16_f32 v58, v64, v65
    v_cvt_pk_bf16_f32 v59, v66, v67
    v_pk_max_i16 v56, v56, 0
    v_pk_max_i16 v57, v57, 0
    v_pk_max_i16 v58, v58, 0
    v_pk_max_i16 v59, v59, 0
    buffer_store_dwordx4 v[56:59], v12, s[56:59], s93 offen offset:2048
    v_mul_f32_e64 v72, v72, |v72|
    v_mul_f32_e64 v73, v73, |v73|
    v_mul_f32_e64 v74, v74, |v74|
    v_mul_f32_e64 v75, v75, |v75|
    v_cvt_pk_bf16_f32 v72, v72, v73
    v_cvt_pk_bf16_f32 v73, v74, v75
    v_pk_max_i16 v72, v72, 0
    v_pk_max_i16 v73, v73, 0
    buffer_store_dwordx2 v[72:73], v13, s[56:59], s93 offen offset:3072
    v_lshlrev_b32 v14, 3, v11
    v_add_u32 v14, v14, v10
    v_sub_u32 v14, 2055, v14
    v_lshrrev_b32 v14, 1, v14
    v_lshlrev_b32 v14, 2, v14
    v_and_b32 v15, 1, v10
    v_mul_u32_u24 v15, 4160, v15
    v_add_u32 v14, v14, v15
    s_lshr_b32 s92, s84, 1
    s_mul_i32 s92, s92, 8320
    s_add_u32 s92, s92, 131072
    s_and_b32 s93, s84, 1
    s_lshl_b32 s93, s93, 8
    s_sub_u32 s92, s92, s93
    s_sub_u32 s95, s92, 512
    v_add_u32 v2, s95, v14
    s_sub_u32 s95, s92, 1536
    v_add_u32 v3, s95, v14
    s_sub_u32 s95, s92, 2560
    v_add_u32 v4, s95, v14
    s_sub_u32 s95, s92, 3584
    v_add_u32 v5, s95, v14
    v_lshlrev_b32 v14, 1, v10
    v_sub_u32 v14, v14, v11
    v_add_u32 v14, 33, v14
    v_lshlrev_b32 v14, 4, v14
    s_lshr_b32 s92, s84, 1
    s_mul_i32 s92, s92, 4608
    s_add_u32 s92, s92, 150304
    s_sub_u32 s92, s92, s93
    v_add_u32 v6, s92, v14
    s_lshl_b32 s92, s88, 2
    s_mul_i32 s92, s92, 57344
    s_mul_i32 s93, s84, 14336
    s_add_u32 s92, s92, s93
    v_lshlrev_b32 v251, 4, v1
    v_add_u32 v251, s92, v251
    v_lshlrev_b32 v252, 3, v1
    s_add_u32 s92, s92, 3072
    v_add_u32 v252, s92, v252
    s_and_b32 s1, s88, 1
    s_and_b32 s92, s2, 7
    s_lshl_b32 s92, s92, 5
    s_bfe_u32 s93, s88, 0x10001
    s_add_u32 s92, s92, s93
    s_lshl_b32 s93, s84, 3
    s_add_u32 s92, s92, s93
    v_and_b32 v18, 3, v1
    v_lshlrev_b32 v18, 1, v18
    v_add_u32 v18, s92, v18
    v_lshlrev_b32 v18, 2, v18
    s_waitcnt vmcnt(0)
    s_cmp_lg_u32 s91, 0
    s_cbranch_scc1 rel_13
    buffer_wbl2 sc1
    s_waitcnt vmcnt(0)
rel_13:
    s_barrier
    ds_read_b128 v[52:55], v6 offset:0
    ds_read2_b32 v[20:21], v2 offset0:128 offset1:129
    ds_read2_b32 v[22:23], v2 offset0:130 offset1:131
    ds_read_b128 v[56:59], v6 offset:512
    ds_read2_b32 v[24:25], v2 offset0:0 offset1:1
    ds_read2_b32 v[26:27], v2 offset0:2 offset1:3
    ds_read_b128 v[60:63], v6 offset:1024
    ds_read2_b32 v[28:29], v3 offset0:128 offset1:129
    ds_read2_b32 v[30:31], v3 offset0:130 offset1:131
    ds_read_b128 v[64:67], v6 offset:1536
    ds_read2_b32 v[32:33], v3 offset0:0 offset1:1
    ds_read2_b32 v[34:35], v3 offset0:2 offset1:3
    ds_read_b128 v[68:71], v6 offset:2048
    ds_read2_b32 v[36:37], v4 offset0:128 offset1:129
    ds_read2_b32 v[38:39], v4 offset0:130 offset1:131
    ds_read_b128 v[72:75], v6 offset:2560
    ds_read2_b32 v[40:41], v4 offset0:0 offset1:1
    ds_read2_b32 v[42:43], v4 offset0:2 offset1:3
    ds_read_b128 v[76:79], v6 offset:3072
    ds_read2_b32 v[44:45], v5 offset0:128 offset1:129
    ds_read2_b32 v[46:47], v5 offset0:130 offset1:131
    ds_read_b128 v[80:83], v6 offset:3584
    ds_read2_b32 v[48:49], v5 offset0:0 offset1:1
    ds_read2_b32 v[50:51], v5 offset0:2 offset1:3
    s_waitcnt lgkmcnt(0)
    v_mfma_f32_16x16x32_bf16 v[176:179], v[20:23], v[52:55], 0
    v_subrev_u32 v2, 64, v2
    v_mfma_f32_16x16x32_bf16 v[180:183], v[20:23], v[56:59], 0
    v_subrev_u32 v3, 64, v3
    v_mfma_f32_16x16x32_bf16 v[184:187], v[20:23], v[60:63], 0
    v_subrev_u32 v4, 64, v4
    v_mfma_f32_16x16x32_bf16 v[188:191], v[20:23], v[64:67], 0
    v_subrev_u32 v5, 64, v5
    v_mfma_f32_16x16x32_bf16 v[192:195], v[20:23], v[68:71], 0
    v_subrev_u32 v6, 64, v6
    v_mfma_f32_16x16x32_bf16 v[196:199], v[20:23], v[72:75], 0
    ds_read_b128 v[116:119], v6 offset:0
    v_mfma_f32_16x16x32_bf16 v[200:203], v[20:23], v[76:79], 0
    ds_read2_b32 v[84:85], v2 offset0:128 offset1:129
    v_mfma_f32_16x16x32_bf16 v[204:207], v[20:23], v[80:83], 0
    ds_read2_b32 v[86:87], v2 offset0:130 offset1:131
    v_mfma_f32_16x16x32_bf16 v[180:183], v[24:27], v[52:55], v[180:183]
    ds_read_b128 v[120:123], v6 offset:512
    v_mfma_f32_16x16x32_bf16 v[184:187], v[24:27], v[56:59], v[184:187]
    ds_read2_b32 v[88:89], v2 offset0:0 offset1:1
    v_mfma_f32_16x16x32_bf16 v[188:191], v[24:27], v[60:63], v[188:191]
    ds_read2_b32 v[90:91], v2 offset0:2 offset1:3
    v_mfma_f32_16x16x32_bf16 v[192:195], v[24:27], v[64:67], v[192:195]
    ds_read_b128 v[124:127], v6 offset:1024
    v_mfma_f32_16x16x32_bf16 v[196:199], v[24:27], v[68:71], v[196:199]
    ds_read2_b32 v[92:93], v3 offset0:128 offset1:129
    v_mfma_f32_16x16x32_bf16 v[200:203], v[24:27], v[72:75], v[200:203]
    ds_read2_b32 v[94:95], v3 offset0:130 offset1:131
    v_mfma_f32_16x16x32_bf16 v[204:207], v[24:27], v[76:79], v[204:207]
    ds_read_b128 v[128:131], v6 offset:1536
    v_mfma_f32_16x16x32_bf16 v[184:187], v[28:31], v[52:55], v[184:187]
    ds_read2_b32 v[96:97], v3 offset0:0 offset1:1
    v_mfma_f32_16x16x32_bf16 v[188:191], v[28:31], v[56:59], v[188:191]
    ds_read2_b32 v[98:99], v3 offset0:2 offset1:3
    v_mfma_f32_16x16x32_bf16 v[192:195], v[28:31], v[60:63], v[192:195]
    ds_read_b128 v[132:135], v6 offset:2048
    v_mfma_f32_16x16x32_bf16 v[196:199], v[28:31], v[64:67], v[196:199]
    ds_read2_b32 v[100:101], v4 offset0:128 offset1:129
    v_mfma_f32_16x16x32_bf16 v[200:203], v[28:31], v[68:71], v[200:203]
    ds_read2_b32 v[102:103], v4 offset0:130 offset1:131
    v_mfma_f32_16x16x32_bf16 v[204:207], v[28:31], v[72:75], v[204:207]
    ds_read_b128 v[136:139], v6 offset:2560
    v_mfma_f32_16x16x32_bf16 v[188:191], v[32:35], v[52:55], v[188:191]
    ds_read2_b32 v[104:105], v4 offset0:0 offset1:1
    v_mfma_f32_16x16x32_bf16 v[192:195], v[32:35], v[56:59], v[192:195]
    ds_read2_b32 v[106:107], v4 offset0:2 offset1:3
    v_mfma_f32_16x16x32_bf16 v[196:199], v[32:35], v[60:63], v[196:199]
    ds_read_b128 v[140:143], v6 offset:3072
    v_mfma_f32_16x16x32_bf16 v[200:203], v[32:35], v[64:67], v[200:203]
    ds_read2_b32 v[108:109], v5 offset0:128 offset1:129
    v_mfma_f32_16x16x32_bf16 v[204:207], v[32:35], v[68:71], v[204:207]
    ds_read2_b32 v[110:111], v5 offset0:130 offset1:131
    v_mfma_f32_16x16x32_bf16 v[192:195], v[36:39], v[52:55], v[192:195]
    ds_read_b128 v[144:147], v6 offset:3584
    v_mfma_f32_16x16x32_bf16 v[196:199], v[36:39], v[56:59], v[196:199]
    ds_read2_b32 v[112:113], v5 offset0:0 offset1:1
    v_mfma_f32_16x16x32_bf16 v[200:203], v[36:39], v[60:63], v[200:203]
    ds_read2_b32 v[114:115], v5 offset0:2 offset1:3
    v_mfma_f32_16x16x32_bf16 v[204:207], v[36:39], v[64:67], v[204:207]
    v_mfma_f32_16x16x32_bf16 v[196:199], v[40:43], v[52:55], v[196:199]
    v_mfma_f32_16x16x32_bf16 v[200:203], v[40:43], v[56:59], v[200:203]
    v_mfma_f32_16x16x32_bf16 v[204:207], v[40:43], v[60:63], v[204:207]
    v_mfma_f32_16x16x32_bf16 v[200:203], v[44:47], v[52:55], v[200:203]
    v_mfma_f32_16x16x32_bf16 v[204:207], v[44:47], v[56:59], v[204:207]
    v_mfma_f32_16x16x32_bf16 v[204:207], v[48:51], v[52:55], v[204:207]
    s_waitcnt lgkmcnt(0)
    buffer_load_dword v19, v18, s[48:51], 0 offen sc1
    v_mfma_f32_16x16x32_bf16 v[176:179], v[84:87], v[116:119], v[176:179]
    v_subrev_u32 v2, 64, v2
    v_mfma_f32_16x16x32_bf16 v[180:183], v[84:87], v[120:123], v[180:183]
    v_subrev_u32 v3, 64, v3
    v_mfma_f32_16x16x32_bf16 v[184:187], v[84:87], v[124:127], v[184:187]
    v_subrev_u32 v4, 64, v4
    v_mfma_f32_16x16x32_bf16 v[188:191], v[84:87], v[128:131], v[188:191]
    v_subrev_u32 v5, 64, v5
    v_mfma_f32_16x16x32_bf16 v[192:195], v[84:87], v[132:135], v[192:195]
    v_subrev_u32 v6, 64, v6
    v_mfma_f32_16x16x32_bf16 v[196:199], v[84:87], v[136:139], v[196:199]
    ds_read_b128 v[52:55], v6 offset:0
    v_mfma_f32_16x16x32_bf16 v[200:203], v[84:87], v[140:143], v[200:203]
    ds_read2_b32 v[20:21], v2 offset0:128 offset1:129
    v_mfma_f32_16x16x32_bf16 v[204:207], v[84:87], v[144:147], v[204:207]
    ds_read2_b32 v[22:23], v2 offset0:130 offset1:131
    v_mfma_f32_16x16x32_bf16 v[180:183], v[88:91], v[116:119], v[180:183]
    ds_read_b128 v[56:59], v6 offset:512
    v_mfma_f32_16x16x32_bf16 v[184:187], v[88:91], v[120:123], v[184:187]
    ds_read2_b32 v[24:25], v2 offset0:0 offset1:1
    v_mfma_f32_16x16x32_bf16 v[188:191], v[88:91], v[124:127], v[188:191]
    ds_read2_b32 v[26:27], v2 offset0:2 offset1:3
    v_mfma_f32_16x16x32_bf16 v[192:195], v[88:91], v[128:131], v[192:195]
    ds_read_b128 v[60:63], v6 offset:1024
    v_mfma_f32_16x16x32_bf16 v[196:199], v[88:91], v[132:135], v[196:199]
    ds_read2_b32 v[28:29], v3 offset0:128 offset1:129
    v_mfma_f32_16x16x32_bf16 v[200:203], v[88:91], v[136:139], v[200:203]
    ds_read2_b32 v[30:31], v3 offset0:130 offset1:131
    v_mfma_f32_16x16x32_bf16 v[204:207], v[88:91], v[140:143], v[204:207]
    ds_read_b128 v[64:67], v6 offset:1536
    v_mfma_f32_16x16x32_bf16 v[184:187], v[92:95], v[116:119], v[184:187]
    ds_read2_b32 v[32:33], v3 offset0:0 offset1:1
    v_mfma_f32_16x16x32_bf16 v[188:191], v[92:95], v[120:123], v[188:191]
    ds_read2_b32 v[34:35], v3 offset0:2 offset1:3
    v_mfma_f32_16x16x32_bf16 v[192:195], v[92:95], v[124:127], v[192:195]
    ds_read_b128 v[68:71], v6 offset:2048
    v_mfma_f32_16x16x32_bf16 v[196:199], v[92:95], v[128:131], v[196:199]
    ds_read2_b32 v[36:37], v4 offset0:128 offset1:129
    v_mfma_f32_16x16x32_bf16 v[200:203], v[92:95], v[132:135], v[200:203]
    ds_read2_b32 v[38:39], v4 offset0:130 offset1:131
    v_mfma_f32_16x16x32_bf16 v[204:207], v[92:95], v[136:139], v[204:207]
    ds_read_b128 v[72:75], v6 offset:2560
    v_mfma_f32_16x16x32_bf16 v[188:191], v[96:99], v[116:119], v[188:191]
    ds_read2_b32 v[40:41], v4 offset0:0 offset1:1
    v_mfma_f32_16x16x32_bf16 v[192:195], v[96:99], v[120:123], v[192:195]
    ds_read2_b32 v[42:43], v4 offset0:2 offset1:3
    v_mfma_f32_16x16x32_bf16 v[196:199], v[96:99], v[124:127], v[196:199]
    ds_read_b128 v[76:79], v6 offset:3072
    v_mfma_f32_16x16x32_bf16 v[200:203], v[96:99], v[128:131], v[200:203]
    ds_read2_b32 v[44:45], v5 offset0:128 offset1:129
    v_mfma_f32_16x16x32_bf16 v[204:207], v[96:99], v[132:135], v[204:207]
    ds_read2_b32 v[46:47], v5 offset0:130 offset1:131
    v_mfma_f32_16x16x32_bf16 v[192:195], v[100:103], v[116:119], v[192:195]
    ds_read_b128 v[80:83], v6 offset:3584
    v_mfma_f32_16x16x32_bf16 v[196:199], v[100:103], v[120:123], v[196:199]
    ds_read2_b32 v[48:49], v5 offset0:0 offset1:1
    v_mfma_f32_16x16x32_bf16 v[200:203], v[100:103], v[124:127], v[200:203]
    ds_read2_b32 v[50:51], v5 offset0:2 offset1:3
    v_mfma_f32_16x16x32_bf16 v[204:207], v[100:103], v[128:131], v[204:207]
    v_mfma_f32_16x16x32_bf16 v[196:199], v[104:107], v[116:119], v[196:199]
    v_mfma_f32_16x16x32_bf16 v[200:203], v[104:107], v[120:123], v[200:203]
    v_mfma_f32_16x16x32_bf16 v[204:207], v[104:107], v[124:127], v[204:207]
    v_mfma_f32_16x16x32_bf16 v[200:203], v[108:111], v[116:119], v[200:203]
    v_mfma_f32_16x16x32_bf16 v[204:207], v[108:111], v[120:123], v[204:207]
    v_mfma_f32_16x16x32_bf16 v[204:207], v[112:115], v[116:119], v[204:207]
    s_waitcnt lgkmcnt(0)
    s_waitcnt vmcnt(0)
    s_mov_b32 s53, 100000
    s_branch pollc_16
poll_14:
    buffer_load_dword v19, v18, s[48:51], 0 offen sc1
    s_waitcnt vmcnt(0)
pollc_16:
    v_cmp_ne_u32 vcc, s90, v19
    s_cmp_eq_u64 vcc, 0
    s_cbranch_scc1 polld_15
    s_sleep 1
    s_sub_u32 s53, s53, 1
    s_cmp_lg_u32 s53, 0
    s_cbranch_scc1 poll_14
polld_15:
    s_cmp_lg_u32 s91, 0
    s_cbranch_scc1 acq_17
    buffer_inv sc1
    s_waitcnt vmcnt(0)
acq_17:
    v_mfma_f32_16x16x32_bf16 v[176:179], v[20:23], v[52:55], v[176:179]
    v_subrev_u32 v2, 64, v2
    v_mfma_f32_16x16x32_bf16 v[180:183], v[20:23], v[56:59], v[180:183]
    v_subrev_u32 v3, 64, v3
    v_mfma_f32_16x16x32_bf16 v[184:187], v[20:23], v[60:63], v[184:187]
    v_subrev_u32 v4, 64, v4
    v_mfma_f32_16x16x32_bf16 v[188:191], v[20:23], v[64:67], v[188:191]
    v_subrev_u32 v5, 64, v5
    s_xor_b32 s0, s1, 0
    s_mul_i32 s0, s0, 7168
    buffer_load_dwordx4 v[148:151], v251, s[56:59], s0 offen offset:0
    v_mfma_f32_16x16x32_bf16 v[192:195], v[20:23], v[68:71], v[192:195]
    v_subrev_u32 v6, 64, v6
    v_mfma_f32_16x16x32_bf16 v[196:199], v[20:23], v[72:75], v[196:199]
    ds_read_b128 v[116:119], v6 offset:0
    v_mfma_f32_16x16x32_bf16 v[200:203], v[20:23], v[76:79], v[200:203]
    ds_read2_b32 v[84:85], v2 offset0:128 offset1:129
    v_mfma_f32_16x16x32_bf16 v[204:207], v[20:23], v[80:83], v[204:207]
    ds_read2_b32 v[86:87], v2 offset0:130 offset1:131
    s_add_u32 s0, s0, 57344
    buffer_load_dwordx4 v[152:155], v251, s[56:59], s0 offen offset:0
    v_mfma_f32_16x16x32_bf16 v[180:183], v[24:27], v[52:55], v[180:183]
    ds_read_b128 v[120:123], v6 offset:512
    v_mfma_f32_16x16x32_bf16 v[184:187], v[24:27], v[56:59], v[184:187]
    ds_read2_b32 v[88:89], v2 offset0:0 offset1:1
    v_mfma_f32_16x16x32_bf16 v[188:191], v[24:27], v[60:63], v[188:191]
    ds_read2_b32 v[90:91], v2 offset0:2 offset1:3
    v_mfma_f32_16x16x32_bf16 v[192:195], v[24:27], v[64:67], v[192:195]
    ds_read_b128 v[124:127], v6 offset:1024
    s_add_u32 s0, s0, 57344
    buffer_load_dwordx4 v[156:159], v251, s[56:59], s0 offen offset:0
    v_mfma_f32_16x16x32_bf16 v[196:199], v[24:27], v[68:71], v[196:199]
    ds_read2_b32 v[92:93], v3 offset0:128 offset1:129
    v_mfma_f32_16x16x32_bf16 v[200:203], v[24:27], v[72:75], v[200:203]
    ds_read2_b32 v[94:95], v3 offset0:130 offset1:131
    v_mfma_f32_16x16x32_bf16 v[204:207], v[24:27], v[76:79], v[204:207]
    ds_read_b128 v[128:131], v6 offset:1536
    v_mfma_f32_16x16x32_bf16 v[184:187], v[28:31], v[52:55], v[184:187]
    ds_read2_b32 v[96:97], v3 offset0:0 offset1:1
    s_add_u32 s0, s0, 57344
    buffer_load_dwordx4 v[160:163], v251, s[56:59], s0 offen offset:0
    v_mfma_f32_16x16x32_bf16 v[188:191], v[28:31], v[56:59], v[188:191]
    ds_read2_b32 v[98:99], v3 offset0:2 offset1:3
    v_mfma_f32_16x16x32_bf16 v[192:195], v[28:31], v[60:63], v[192:195]
    ds_read_b128 v[132:135], v6 offset:2048
    v_mfma_f32_16x16x32_bf16 v[196:199], v[28:31], v[64:67], v[196:199]
    ds_read2_b32 v[100:101], v4 offset0:128 offset1:129
    v_mfma_f32_16x16x32_bf16 v[200:203], v[28:31], v[68:71], v[200:203]
    ds_read2_b32 v[102:103], v4 offset0:130 offset1:131
    s_xor_b32 s0, s1, 0
    s_mul_i32 s0, s0, 7168
    buffer_load_dwordx4 v[164:167], v251, s[56:59], s0 offen offset:1024
    v_mfma_f32_16x16x32_bf16 v[204:207], v[28:31], v[72:75], v[204:207]
    ds_read_b128 v[136:139], v6 offset:2560
    v_mfma_f32_16x16x32_bf16 v[188:191], v[32:35], v[52:55], v[188:191]
    ds_read2_b32 v[104:105], v4 offset0:0 offset1:1
    v_mfma_f32_16x16x32_bf16 v[192:195], v[32:35], v[56:59], v[192:195]
    ds_read2_b32 v[106:107], v4 offset0:2 offset1:3
    v_mfma_f32_16x16x32_bf16 v[196:199], v[32:35], v[60:63], v[196:199]
    ds_read_b128 v[140:143], v6 offset:3072
    s_add_u32 s0, s0, 57344
    buffer_load_dwordx4 v[168:171], v251, s[56:59], s0 offen offset:1024
    v_mfma_f32_16x16x32_bf16 v[200:203], v[32:35], v[64:67], v[200:203]
    ds_read2_b32 v[108:109], v5 offset0:128 offset1:129
    v_mfma_f32_16x16x32_bf16 v[204:207], v[32:35], v[68:71], v[204:207]
    ds_read2_b32 v[110:111], v5 offset0:130 offset1:131
    v_mfma_f32_16x16x32_bf16 v[192:195], v[36:39], v[52:55], v[192:195]
    ds_read_b128 v[144:147], v6 offset:3584
    v_mfma_f32_16x16x32_bf16 v[196:199], v[36:39], v[56:59], v[196:199]
    ds_read2_b32 v[112:113], v5 offset0:0 offset1:1
    s_add_u32 s0, s0, 57344
    buffer_load_dwordx4 v[172:175], v251, s[56:59], s0 offen offset:1024
    v_mfma_f32_16x16x32_bf16 v[200:203], v[36:39], v[60:63], v[200:203]
    ds_read2_b32 v[114:115], v5 offset0:2 offset1:3
    v_mfma_f32_16x16x32_bf16 v[204:207], v[36:39], v[64:67], v[204:207]
    v_mfma_f32_16x16x32_bf16 v[196:199], v[40:43], v[52:55], v[196:199]
    v_mfma_f32_16x16x32_bf16 v[200:203], v[40:43], v[56:59], v[200:203]
    s_add_u32 s0, s0, 57344
    buffer_load_dwordx4 v[220:223], v251, s[56:59], s0 offen offset:1024
    v_mfma_f32_16x16x32_bf16 v[204:207], v[40:43], v[60:63], v[204:207]
    v_mfma_f32_16x16x32_bf16 v[200:203], v[44:47], v[52:55], v[200:203]
    v_mfma_f32_16x16x32_bf16 v[204:207], v[44:47], v[56:59], v[204:207]
    v_mfma_f32_16x16x32_bf16 v[204:207], v[48:51], v[52:55], v[204:207]
    s_waitcnt lgkmcnt(0)
    v_mfma_f32_16x16x32_bf16 v[176:179], v[84:87], v[116:119], v[176:179]
    v_mfma_f32_16x16x32_bf16 v[180:183], v[84:87], v[120:123], v[180:183]
    v_mfma_f32_16x16x32_bf16 v[184:187], v[84:87], v[124:127], v[184:187]
    v_mfma_f32_16x16x32_bf16 v[188:191], v[84:87], v[128:131], v[188:191]
    s_xor_b32 s0, s1, 0
    s_mul_i32 s0, s0, 7168
    buffer_load_dwordx4 v[224:227], v251, s[56:59], s0 offen offset:2048
    v_mfma_f32_16x16x32_bf16 v[192:195], v[84:87], v[132:135], v[192:195]
    v_mfma_f32_16x16x32_bf16 v[196:199], v[84:87], v[136:139], v[196:199]
    v_mfma_f32_16x16x32_bf16 v[200:203], v[84:87], v[140:143], v[200:203]
    v_mfma_f32_16x16x32_bf16 v[204:207], v[84:87], v[144:147], v[204:207]
    s_add_u32 s0, s0, 57344
    buffer_load_dwordx4 v[228:231], v251, s[56:59], s0 offen offset:2048
    v_mfma_f32_16x16x32_bf16 v[180:183], v[88:91], v[116:119], v[180:183]
    v_mfma_f32_16x16x32_bf16 v[184:187], v[88:91], v[120:123], v[184:187]
    v_mfma_f32_16x16x32_bf16 v[188:191], v[88:91], v[124:127], v[188:191]
    v_mfma_f32_16x16x32_bf16 v[192:195], v[88:91], v[128:131], v[192:195]
    s_add_u32 s0, s0, 57344
    buffer_load_dwordx4 v[232:235], v251, s[56:59], s0 offen offset:2048
    v_mfma_f32_16x16x32_bf16 v[196:199], v[88:91], v[132:135], v[196:199]
    v_mfma_f32_16x16x32_bf16 v[200:203], v[88:91], v[136:139], v[200:203]
    v_mfma_f32_16x16x32_bf16 v[204:207], v[88:91], v[140:143], v[204:207]
    v_mfma_f32_16x16x32_bf16 v[184:187], v[92:95], v[116:119], v[184:187]
    s_add_u32 s0, s0, 57344
    buffer_load_dwordx4 v[236:239], v251, s[56:59], s0 offen offset:2048
    v_mfma_f32_16x16x32_bf16 v[188:191], v[92:95], v[120:123], v[188:191]
    v_mfma_f32_16x16x32_bf16 v[192:195], v[92:95], v[124:127], v[192:195]
    v_mfma_f32_16x16x32_bf16 v[196:199], v[92:95], v[128:131], v[196:199]
    v_mfma_f32_16x16x32_bf16 v[200:203], v[92:95], v[132:135], v[200:203]
    v_mfma_f32_16x16x32_bf16 v[204:207], v[92:95], v[136:139], v[204:207]
    v_mfma_f32_16x16x32_bf16 v[188:191], v[96:99], v[116:119], v[188:191]
    v_mfma_f32_16x16x32_bf16 v[192:195], v[96:99], v[120:123], v[192:195]
    v_mfma_f32_16x16x32_bf16 v[196:199], v[96:99], v[124:127], v[196:199]
    v_mfma_f32_16x16x32_bf16 v[200:203], v[96:99], v[128:131], v[200:203]
    v_mfma_f32_16x16x32_bf16 v[204:207], v[96:99], v[132:135], v[204:207]
    v_mfma_f32_16x16x32_bf16 v[192:195], v[100:103], v[116:119], v[192:195]
    v_mfma_f32_16x16x32_bf16 v[196:199], v[100:103], v[120:123], v[196:199]
    v_mfma_f32_16x16x32_bf16 v[200:203], v[100:103], v[124:127], v[200:203]
    v_mfma_f32_16x16x32_bf16 v[204:207], v[100:103], v[128:131], v[204:207]
    v_mfma_f32_16x16x32_bf16 v[196:199], v[104:107], v[116:119], v[196:199]
    v_mfma_f32_16x16x32_bf16 v[200:203], v[104:107], v[120:123], v[200:203]
    v_mfma_f32_16x16x32_bf16 v[204:207], v[104:107], v[124:127], v[204:207]
    v_mfma_f32_16x16x32_bf16 v[200:203], v[108:111], v[116:119], v[200:203]
    v_mfma_f32_16x16x32_bf16 v[204:207], v[108:111], v[120:123], v[204:207]
    v_mfma_f32_16x16x32_bf16 v[204:207], v[112:115], v[116:119], v[204:207]
    s_lshl_b32 s92, s84, 12
    s_add_u32 s92, s92, 114688
    v_lshlrev_b32 v12, 4, v1
    v_add_u32 v13, s92, v12
    s_xor_b32 s93, s84, 1
    s_lshl_b32 s93, s93, 12
    s_add_u32 s93, s93, 114688
    v_add_u32 v14, s93, v12
    v_lshlrev_b32 v15, 5, v10
    v_lshl_add_u32 v15, v11, 3, v15
    s_and_b32 s94, s84, 1
    s_lshl_b32 s94, s94, 11
    s_lshr_b32 s92, s84, 1
    s_mul_i32 s92, s92, 4608
    s_add_u32 s92, s92, 150816
    s_add_u32 s92, s92, s94
    v_add_u32 v16, s92, v15
    ds_read_b64 v[20:21], v16 offset:0
    ds_read_b64 v[22:23], v16 offset:512
    ds_read_b64 v[24:25], v16 offset:1024
    ds_read_b64 v[26:27], v16 offset:1536
    s_bitcmp1_b32 s84, 0
    s_cbranch_scc1 b1_18
    ds_write_b128 v13, v[192:195] offset:0
    ds_write_b128 v13, v[196:199] offset:1024
    ds_write_b128 v13, v[200:203] offset:2048
    ds_write_b128 v13, v[204:207] offset:3072
    s_branch bj_19
b1_18:
    ds_write_b128 v13, v[176:179] offset:0
    ds_write_b128 v13, v[180:183] offset:1024
    ds_write_b128 v13, v[184:187] offset:2048
    ds_write_b128 v13, v[188:191] offset:3072
    s_nop 1
    v_mov_b32 v176, v192
    v_mov_b32 v177, v193
    v_mov_b32 v178, v194
    v_mov_b32 v179, v195
    v_mov_b32 v180, v196
    v_mov_b32 v181, v197
    v_mov_b32 v182, v198
    v_mov_b32 v183, v199
    v_mov_b32 v184, v200
    v_mov_b32 v185, v201
    v_mov_b32 v186, v202
    v_mov_b32 v187, v203
    v_mov_b32 v188, v204
    v_mov_b32 v189, v205
    v_mov_b32 v190, v206
    v_mov_b32 v191, v207
bj_19:
    s_lshl_b32 s92, s3, 12
    s_add_u32 s92, s92, s94
    v_add_u32 v16, s92, v15
    v_lshlrev_b32 v250, 16, v250
    s_mov_b32 s92, 0xffff0000
    s_waitcnt lgkmcnt(4)
    v_lshlrev_b32 v28, 16, v20
    v_and_b32 v29, s92, v20
    v_lshlrev_b32 v30, 16, v21
    v_and_b32 v31, s92, v21
    v_mul_f32 v28, v28, v250
    v_mul_f32 v29, v29, v250
    v_mul_f32 v30, v30, v250
    v_mul_f32 v31, v31, v250
    v_cvt_pk_bf16_f32 v20, v28, v29
    v_cvt_pk_bf16_f32 v21, v30, v31
    v_lshlrev_b32 v28, 16, v20
    v_and_b32 v29, s92, v20
    v_lshlrev_b32 v30, 16, v21
    v_and_b32 v31, s92, v21
    v_lshlrev_b32 v32, 16, v22
    v_and_b32 v33, s92, v22
    v_lshlrev_b32 v34, 16, v23
    v_and_b32 v35, s92, v23
    v_mul_f32 v32, v32, v250
    v_mul_f32 v33, v33, v250
    v_mul_f32 v34, v34, v250
    v_mul_f32 v35, v35, v250
    v_cvt_pk_bf16_f32 v22, v32, v33
    v_cvt_pk_bf16_f32 v23, v34, v35
    v_lshlrev_b32 v32, 16, v22
    v_and_b32 v33, s92, v22
    v_lshlrev_b32 v34, 16, v23
    v_and_b32 v35, s92, v23
    v_lshlrev_b32 v36, 16, v24
    v_and_b32 v37, s92, v24
    v_lshlrev_b32 v38, 16, v25
    v_and_b32 v39, s92, v25
    v_mul_f32 v36, v36, v250
    v_mul_f32 v37, v37, v250
    v_mul_f32 v38, v38, v250
    v_mul_f32 v39, v39, v250
    v_cvt_pk_bf16_f32 v24, v36, v37
    v_cvt_pk_bf16_f32 v25, v38, v39
    v_lshlrev_b32 v36, 16, v24
    v_and_b32 v37, s92, v24
    v_lshlrev_b32 v38, 16, v25
    v_and_b32 v39, s92, v25
    v_lshlrev_b32 v40, 16, v26
    v_and_b32 v41, s92, v26
    v_lshlrev_b32 v42, 16, v27
    v_and_b32 v43, s92, v27
    v_mul_f32 v40, v40, v250
    v_mul_f32 v41, v41, v250
    v_mul_f32 v42, v42, v250
    v_mul_f32 v43, v43, v250
    v_cvt_pk_bf16_f32 v26, v40, v41
    v_cvt_pk_bf16_f32 v27, v42, v43
    v_lshlrev_b32 v40, 16, v26
    v_and_b32 v41, s92, v26
    v_lshlrev_b32 v42, 16, v27
    v_and_b32 v43, s92, v27
    s_waitcnt lgkmcnt(0)
    s_add_u32 s92, s90, 3
    s_lshl_b32 s93, s84, 2
    s_add_u32 s93, s93, 162688
    v_mov_b32 v18, s93
    v_mov_b32 v19, s92
    ds_write_b32 v18, v19
    v_and_b32 v18, 3, v1
    v_lshlrev_b32 v18, 2, v18
    v_add_u32 v18, 162688, v18
    s_mov_b32 s53, 1600000
lsync_20:
    ds_read_b32 v19, v18
    s_waitcnt lgkmcnt(0)
    v_cmp_ne_u32 vcc, s92, v19
    s_cmp_eq_u64 vcc, 0
    s_cbranch_scc1 lsyncd_21
    s_sub_u32 s53, s53, 1
    s_cmp_lg_u32 s53, 0
    s_cbranch_scc1 lsync_20
lsyncd_21:
    s_mov_b32 s92, 0xffff0000
    ds_read_b128 v[48:51], v14 offset:0
    ds_read_b128 v[52:55], v14 offset:1024
    ds_read_b128 v[56:59], v14 offset:2048
    ds_read_b128 v[60:63], v14 offset:3072
    s_waitcnt lgkmcnt(0)
    v_add_f32 v176, v176, v48
    v_add_f32 v177, v177, v49
    v_add_f32 v178, v178, v50
    v_add_f32 v179, v179, v51
    v_cvt_pk_bf16_f32 v176, v176, v177
    v_cvt_pk_bf16_f32 v177, v178, v179
    v_lshlrev_b32 v64, 16, v176
    v_and_b32 v65, s92, v176
    v_lshlrev_b32 v66, 16, v177
    v_and_b32 v67, s92, v177
    v_add_f32 v64, v64, v28
    v_add_f32 v65, v65, v29
    v_add_f32 v66, v66, v30
    v_add_f32 v67, v67, v31
    v_cvt_pk_bf16_f32 v176, v64, v65
    v_cvt_pk_bf16_f32 v177, v66, v67
    buffer_store_dwordx2 v[176:177], v16, s[68:71], 0 offen offset:0 sc1
    v_add_f32 v180, v180, v52
    v_add_f32 v181, v181, v53
    v_add_f32 v182, v182, v54
    v_add_f32 v183, v183, v55
    v_cvt_pk_bf16_f32 v180, v180, v181
    v_cvt_pk_bf16_f32 v181, v182, v183
    v_lshlrev_b32 v64, 16, v180
    v_and_b32 v65, s92, v180
    v_lshlrev_b32 v66, 16, v181
    v_and_b32 v67, s92, v181
    v_add_f32 v64, v64, v32
    v_add_f32 v65, v65, v33
    v_add_f32 v66, v66, v34
    v_add_f32 v67, v67, v35
    v_cvt_pk_bf16_f32 v180, v64, v65
    v_cvt_pk_bf16_f32 v181, v66, v67
    buffer_store_dwordx2 v[180:181], v16, s[68:71], 0 offen offset:512 sc1
    v_add_f32 v184, v184, v56
    v_add_f32 v185, v185, v57
    v_add_f32 v186, v186, v58
    v_add_f32 v187, v187, v59
    v_cvt_pk_bf16_f32 v184, v184, v185
    v_cvt_pk_bf16_f32 v185, v186, v187
    v_lshlrev_b32 v64, 16, v184
    v_and_b32 v65, s92, v184
    v_lshlrev_b32 v66, 16, v185
    v_and_b32 v67, s92, v185
    v_add_f32 v64, v64, v36
    v_add_f32 v65, v65, v37
    v_add_f32 v66, v66, v38
    v_add_f32 v67, v67, v39
    v_cvt_pk_bf16_f32 v184, v64, v65
    v_cvt_pk_bf16_f32 v185, v66, v67
    buffer_store_dwordx2 v[184:185], v16, s[68:71], 0 offen offset:1024 sc1
    v_add_f32 v188, v188, v60
    v_add_f32 v189, v189, v61
    v_add_f32 v190, v190, v62
    v_add_f32 v191, v191, v63
    v_cvt_pk_bf16_f32 v188, v188, v189
    v_cvt_pk_bf16_f32 v189, v190, v191
    v_lshlrev_b32 v64, 16, v188
    v_and_b32 v65, s92, v188
    v_lshlrev_b32 v66, 16, v189
    v_and_b32 v67, s92, v189
    v_add_f32 v64, v64, v40
    v_add_f32 v65, v65, v41
    v_add_f32 v66, v66, v42
    v_add_f32 v67, v67, v43
    v_cvt_pk_bf16_f32 v188, v64, v65
    v_cvt_pk_bf16_f32 v189, v66, v67
    buffer_store_dwordx2 v[188:189], v16, s[68:71], 0 offen offset:1536 sc1
    s_mov_b32 s92, 0xffff0000
    v_lshlrev_b32 v52, 16, v216
    v_and_b32 v53, s92, v216
    v_lshlrev_b32 v60, 16, v208
    v_and_b32 v61, s92, v208
    v_lshlrev_b32 v68, 16, v212
    v_and_b32 v69, s92, v212
    v_lshlrev_b32 v54, 16, v217
    v_and_b32 v55, s92, v217
    v_lshlrev_b32 v62, 16, v209
    v_and_b32 v63, s92, v209
    v_lshlrev_b32 v70, 16, v213
    v_and_b32 v71, s92, v213
    v_lshlrev_b32 v56, 16, v218
    v_and_b32 v57, s92, v218
    v_lshlrev_b32 v64, 16, v210
    v_and_b32 v65, s92, v210
    v_lshlrev_b32 v72, 16, v214
    v_and_b32 v73, s92, v214
    v_lshlrev_b32 v58, 16, v219
    v_and_b32 v59, s92, v219
    v_lshlrev_b32 v66, 16, v211
    v_and_b32 v67, s92, v211
    v_lshlrev_b32 v74, 16, v215
    v_and_b32 v75, s92, v215
    v_mul_f32 v60, v60, v52
    v_mul_f32 v68, v68, v52
    v_mul_f32 v61, v61, v53
    v_mul_f32 v69, v69, v53
    v_mul_f32 v62, v62, v54
    v_mul_f32 v70, v70, v54
    v_mul_f32 v63, v63, v55
    v_mul_f32 v71, v71, v55
    v_mul_f32 v64, v64, v56
    v_mul_f32 v72, v72, v56
    v_mul_f32 v65, v65, v57
    v_mul_f32 v73, v73, v57
    v_mul_f32 v66, v66, v58
    v_mul_f32 v74, v74, v58
    v_mul_f32 v67, v67, v59
    v_mul_f32 v75, v75, v59
    v_cvt_pk_bf16_f32 v60, v60, v61
    v_cvt_pk_bf16_f32 v68, v68, v69
    v_cvt_pk_bf16_f32 v61, v62, v63
    v_cvt_pk_bf16_f32 v69, v70, v71
    v_cvt_pk_bf16_f32 v62, v64, v65
    v_cvt_pk_bf16_f32 v70, v72, v73
    v_cvt_pk_bf16_f32 v63, v66, v67
    v_cvt_pk_bf16_f32 v71, v74, v75
    v_mov_b32 v76, 0
    v_mov_b32 v77, 0
    s_mov_b32 s93, 0x3f803f80
    v_dot2_f32_bf16 v76, v60, s93, v76
    v_dot2_f32_bf16 v77, v68, s93, v77
    v_dot2_f32_bf16 v76, v61, s93, v76
    v_dot2_f32_bf16 v77, v69, s93, v77
    v_dot2_f32_bf16 v76, v62, s93, v76
    v_dot2_f32_bf16 v77, v70, s93, v77
    v_dot2_f32_bf16 v76, v63, s93, v76
    v_dot2_f32_bf16 v77, v71, s93, v77
    s_nop 2
    s_nop 1
    v_add_f32_dpp v76, v76, v76 row_shr:1 row_mask:0xf bank_mask:0xf bound_ctrl:0
    v_add_f32_dpp v77, v77, v77 row_shr:1 row_mask:0xf bank_mask:0xf bound_ctrl:0
    s_nop 1
    v_add_f32_dpp v76, v76, v76 row_shr:2 row_mask:0xf bank_mask:0xf bound_ctrl:0
    v_add_f32_dpp v77, v77, v77 row_shr:2 row_mask:0xf bank_mask:0xf bound_ctrl:0
    s_nop 1
    v_add_f32_dpp v76, v76, v76 row_shr:4 row_mask:0xf bank_mask:0xf bound_ctrl:0
    v_add_f32_dpp v77, v77, v77 row_shr:4 row_mask:0xf bank_mask:0xf bound_ctrl:0
    s_nop 1
    v_add_f32_dpp v76, v76, v76 row_shr:8 row_mask:0xf bank_mask:0xf bound_ctrl:0
    v_add_f32_dpp v77, v77, v77 row_shr:8 row_mask:0xf bank_mask:0xf bound_ctrl:0
    s_nop 1
    v_add_f32_dpp v76, v76, v76 row_bcast:15 row_mask:0xa bank_mask:0xf
    v_add_f32_dpp v77, v77, v77 row_bcast:15 row_mask:0xa bank_mask:0xf
    s_nop 1
    v_add_f32_dpp v76, v76, v76 row_bcast:31 row_mask:0xc bank_mask:0xf
    v_add_f32_dpp v77, v77, v77 row_bcast:31 row_mask:0xc bank_mask:0xf
    s_nop 1
    v_cvt_pk_bf16_f32 v76, v76, v76
    v_cvt_pk_bf16_f32 v77, v77, v77
    v_lshlrev_b32 v76, 16, v76
    v_lshlrev_b32 v77, 16, v77
    v_mul_f32 v76, 0xbfb8aa3b, v76
    v_mul_f32 v77, 0xbfb8aa3b, v77
    v_exp_f32 v76, v76
    v_exp_f32 v77, v77
    s_nop 0
    v_add_f32 v76, 1.0, v76
    v_add_f32 v77, 1.0, v77
    v_rcp_f32 v76, v76
    v_rcp_f32 v77, v77
    s_nop 0
    v_cvt_pk_bf16_f32 v76, v76, v76
    v_cvt_pk_bf16_f32 v77, v77, v77
    v_lshlrev_b32 v76, 16, v76
    v_lshlrev_b32 v77, 16, v77
    s_add_u32 s76, s38, 12582912
    s_addc_u32 s77, s39, 0
    s_mov_b32 s78, 8192
    s_mov_b32 s79, 0x20000
    s_lshl_b32 s92, s85, 3
    s_lshl_b32 s93, s84, 1
    s_add_u32 s92, s92, s93
    s_lshl_b32 s92, s92, 2
    v_mov_b32 v12, s92
    s_mov_b32 exec_lo, 0
    s_mov_b32 exec_hi, 0x80000000
    buffer_store_dwordx2 v[76:77], v12, s[76:79], 0 offen sc1
    s_mov_b64 exec, -1
    s_xor_b32 s0, s1, 0
    s_mul_i32 s0, s0, 7168
    s_add_u32 s0, s0, 3584
    buffer_load_dwordx4 v[116:119], v251, s[56:59], s0 offen offset:0
    s_add_u32 s0, s0, 57344
    buffer_load_dwordx4 v[120:123], v251, s[56:59], s0 offen offset:0
    s_add_u32 s0, s0, 57344
    buffer_load_dwordx4 v[124:127], v251, s[56:59], s0 offen offset:0
    s_add_u32 s0, s0, 57344
    buffer_load_dwordx4 v[128:131], v251, s[56:59], s0 offen offset:0
    s_xor_b32 s0, s1, 0
    s_mul_i32 s0, s0, 7168
    s_add_u32 s0, s0, 3584
    buffer_load_dwordx4 v[132:135], v251, s[56:59], s0 offen offset:1024
    s_add_u32 s0, s0, 57344
    buffer_load_dwordx4 v[136:139], v251, s[56:59], s0 offen offset:1024
    s_add_u32 s0, s0, 57344
    buffer_load_dwordx4 v[140:143], v251, s[56:59], s0 offen offset:1024
    s_add_u32 s0, s0, 57344
    buffer_load_dwordx4 v[144:147], v251, s[56:59], s0 offen offset:1024
    v_lshrrev_b32 v12, 2, v1
    v_lshlrev_b32 v12, 7, v12
    v_and_b32 v13, 3, v1
    v_lshl_add_u32 v12, v13, 3, v12
    s_lshl_b32 s92, s84, 12
    v_add_u32 v12, s92, v12
    v_bfe_u32 v13, v1, 3, 2
    v_xor_b32 v2, 0, v13
    v_lshl_add_u32 v2, v2, 5, v12
    v_add_u32 v6, 65536, v2
    v_add_u32 v246, 131072, v2
    v_xor_b32 v3, 1, v13
    v_lshl_add_u32 v3, v3, 5, v12
    v_add_u32 v7, 65536, v3
    v_add_u32 v247, 131072, v3
    v_xor_b32 v4, 2, v13
    v_lshl_add_u32 v4, v4, 5, v12
    v_add_u32 v8, 65536, v4
    v_add_u32 v248, 131072, v4
    v_xor_b32 v5, 3, v13
    v_lshl_add_u32 v5, v5, 5, v12
    v_add_u32 v9, 65536, v5
    v_add_u32 v249, 131072, v5
    v_lshlrev_b32 v17, 3, v11
    s_lshl_b32 s92, s89, 7
    v_add_u32 v17, s92, v17
    s_waitcnt vmcnt(8)
    s_barrier
    ds_read_b64_tr_b16 v[84:85], v2 offset:0
    ds_read_b64_tr_b16 v[86:87], v2 offset:2048
    ds_read_b64_tr_b16 v[88:89], v3 offset:0
    ds_read_b64_tr_b16 v[90:91], v3 offset:2048
    ds_read_b64_tr_b16 v[92:93], v4 offset:0
    ds_read_b64_tr_b16 v[94:95], v4 offset:2048
    ds_read_b64_tr_b16 v[96:97], v5 offset:0
    ds_read_b64_tr_b16 v[98:99], v5 offset:2048
    s_waitcnt lgkmcnt(0)
    s_barrier
    s_xor_b32 s0, s1, 0
    s_mul_i32 s0, s0, 7168
    s_add_u32 s0, s0, 3584
    buffer_load_dwordx4 v[176:179], v251, s[56:59], s0 offen offset:2048
    s_add_u32 s0, s0, 57344
    buffer_load_dwordx4 v[180:183], v251, s[56:59], s0 offen offset:2048
    s_add_u32 s0, s0, 57344
    buffer_load_dwordx4 v[184:187], v251, s[56:59], s0 offen offset:2048
    s_add_u32 s0, s0, 57344
    buffer_load_dwordx4 v[188:191], v251, s[56:59], s0 offen offset:2048
    s_xor_b32 s0, s1, 0
    s_mul_i32 s0, s0, 7168
    buffer_load_dwordx2 v[192:193], v252, s[56:59], s0 offen
    buffer_load_dwordx2 v[194:195], v252, s[56:59], s0 offen offset:3584
    s_add_u32 s0, s0, 57344
    buffer_load_dwordx2 v[196:197], v252, s[56:59], s0 offen
    buffer_load_dwordx2 v[198:199], v252, s[56:59], s0 offen offset:3584
    s_add_u32 s0, s0, 57344
    buffer_load_dwordx2 v[200:201], v252, s[56:59], s0 offen
    buffer_load_dwordx2 v[202:203], v252, s[56:59], s0 offen offset:3584
    s_add_u32 s0, s0, 57344
    buffer_load_dwordx2 v[204:205], v252, s[56:59], s0 offen
    buffer_load_dwordx2 v[206:207], v252, s[56:59], s0 offen offset:3584
    s_xor_b32 s0, s1, 1
    s_mul_i32 s0, s0, 7168
    v_mfma_f32_16x16x32_bf16 v[20:23], v[84:87], v[148:151], 0
    ds_read_b64_tr_b16 v[100:101], v2 offset:16384
    v_mfma_f32_16x16x32_bf16 v[24:27], v[88:91], v[148:151], 0
    ds_read_b64_tr_b16 v[102:103], v2 offset:18432
    v_mfma_f32_16x16x32_bf16 v[28:31], v[92:95], v[148:151], 0
    ds_read_b64_tr_b16 v[104:105], v3 offset:16384
    v_mfma_f32_16x16x32_bf16 v[32:35], v[96:99], v[148:151], 0
    ds_read_b64_tr_b16 v[106:107], v3 offset:18432
    buffer_load_dwordx4 v[148:151], v251, s[56:59], s0 offen offset:1024
    v_mfma_f32_16x16x32_bf16 v[36:39], v[84:87], v[152:155], 0
    ds_read_b64_tr_b16 v[108:109], v4 offset:16384
    v_mfma_f32_16x16x32_bf16 v[40:43], v[88:91], v[152:155], 0
    ds_read_b64_tr_b16 v[110:111], v4 offset:18432
    v_mfma_f32_16x16x32_bf16 v[44:47], v[92:95], v[152:155], 0
    ds_read_b64_tr_b16 v[112:113], v5 offset:16384
    v_mfma_f32_16x16x32_bf16 v[48:51], v[96:99], v[152:155], 0
    ds_read_b64_tr_b16 v[114:115], v5 offset:18432
    s_add_u32 s0, s0, 57344
    buffer_load_dwordx4 v[152:155], v251, s[56:59], s0 offen offset:1024
    v_mfma_f32_16x16x32_bf16 v[52:55], v[84:87], v[156:159], 0
    v_mfma_f32_16x16x32_bf16 v[56:59], v[88:91], v[156:159], 0
    v_mfma_f32_16x16x32_bf16 v[60:63], v[92:95], v[156:159], 0
    v_mfma_f32_16x16x32_bf16 v[64:67], v[96:99], v[156:159], 0
    s_add_u32 s0, s0, 57344
    buffer_load_dwordx4 v[156:159], v251, s[56:59], s0 offen offset:1024
    v_mfma_f32_16x16x32_bf16 v[68:71], v[84:87], v[160:163], 0
    v_mfma_f32_16x16x32_bf16 v[72:75], v[88:91], v[160:163], 0
    v_mfma_f32_16x16x32_bf16 v[76:79], v[92:95], v[160:163], 0
    v_mfma_f32_16x16x32_bf16 v[80:83], v[96:99], v[160:163], 0
    s_add_u32 s0, s0, 57344
    buffer_load_dwordx4 v[160:163], v251, s[56:59], s0 offen offset:1024
    s_waitcnt lgkmcnt(0)
    s_barrier
    s_xor_b32 s0, s1, 1
    s_mul_i32 s0, s0, 7168
    buffer_load_dwordx4 v[208:211], v251, s[56:59], s0 offen offset:0
    s_add_u32 s0, s0, 57344
    buffer_load_dwordx4 v[212:215], v251, s[56:59], s0 offen offset:0
    s_add_u32 s0, s0, 57344
    buffer_load_dwordx4 v[216:219], v251, s[56:59], s0 offen offset:0
    s_add_u32 s0, s0, 57344
    buffer_load_dwordx4 v[240:243], v251, s[56:59], s0 offen offset:0
    s_xor_b32 s0, s1, 1
    s_mul_i32 s0, s0, 7168
    v_mfma_f32_16x16x32_bf16 v[20:23], v[100:103], v[164:167], v[20:23]
    ds_read_b64_tr_b16 v[84:85], v2 offset:32768
    v_mfma_f32_16x16x32_bf16 v[24:27], v[104:107], v[164:167], v[24:27]
    ds_read_b64_tr_b16 v[86:87], v2 offset:34816
    v_mfma_f32_16x16x32_bf16 v[28:31], v[108:111], v[164:167], v[28:31]
    ds_read_b64_tr_b16 v[88:89], v3 offset:32768
    v_mfma_f32_16x16x32_bf16 v[32:35], v[112:115], v[164:167], v[32:35]
    ds_read_b64_tr_b16 v[90:91], v3 offset:34816
    buffer_load_dwordx4 v[164:167], v251, s[56:59], s0 offen offset:2048
    v_mfma_f32_16x16x32_bf16 v[36:39], v[100:103], v[168:171], v[36:39]
    ds_read_b64_tr_b16 v[92:93], v4 offset:32768
    v_mfma_f32_16x16x32_bf16 v[40:43], v[104:107], v[168:171], v[40:43]
    ds_read_b64_tr_b16 v[94:95], v4 offset:34816
    v_mfma_f32_16x16x32_bf16 v[44:47], v[108:111], v[168:171], v[44:47]
    ds_read_b64_tr_b16 v[96:97], v5 offset:32768
    v_mfma_f32_16x16x32_bf16 v[48:51], v[112:115], v[168:171], v[48:51]
    ds_read_b64_tr_b16 v[98:99], v5 offset:34816
    s_add_u32 s0, s0, 57344
    buffer_load_dwordx4 v[168:171], v251, s[56:59], s0 offen offset:2048
    v_mfma_f32_16x16x32_bf16 v[52:55], v[100:103], v[172:175], v[52:55]
    v_mfma_f32_16x16x32_bf16 v[56:59], v[104:107], v[172:175], v[56:59]
    v_mfma_f32_16x16x32_bf16 v[60:63], v[108:111], v[172:175], v[60:63]
    v_mfma_f32_16x16x32_bf16 v[64:67], v[112:115], v[172:175], v[64:67]
    s_add_u32 s0, s0, 57344
    buffer_load_dwordx4 v[172:175], v251, s[56:59], s0 offen offset:2048
    v_mfma_f32_16x16x32_bf16 v[68:71], v[100:103], v[220:223], v[68:71]
    v_mfma_f32_16x16x32_bf16 v[72:75], v[104:107], v[220:223], v[72:75]
    v_mfma_f32_16x16x32_bf16 v[76:79], v[108:111], v[220:223], v[76:79]
    v_mfma_f32_16x16x32_bf16 v[80:83], v[112:115], v[220:223], v[80:83]
    s_add_u32 s0, s0, 57344
    buffer_load_dwordx4 v[220:223], v251, s[56:59], s0 offen offset:2048
    s_waitcnt lgkmcnt(0)
    s_barrier
    s_xor_b32 s0, s1, 1
    s_mul_i32 s0, s0, 7168
    s_add_u32 s0, s0, 3584
    v_mfma_f32_16x16x32_bf16 v[20:23], v[84:87], v[224:227], v[20:23]
    ds_read_b64_tr_b16 v[100:101], v2 offset:49152
    v_mfma_f32_16x16x32_bf16 v[24:27], v[88:91], v[224:227], v[24:27]
    ds_read_b64_tr_b16 v[102:103], v2 offset:51200
    v_mfma_f32_16x16x32_bf16 v[28:31], v[92:95], v[224:227], v[28:31]
    ds_read_b64_tr_b16 v[104:105], v3 offset:49152
    v_mfma_f32_16x16x32_bf16 v[32:35], v[96:99], v[224:227], v[32:35]
    ds_read_b64_tr_b16 v[106:107], v3 offset:51200
    buffer_load_dwordx4 v[224:227], v251, s[56:59], s0 offen offset:0
    v_mfma_f32_16x16x32_bf16 v[36:39], v[84:87], v[228:231], v[36:39]
    ds_read_b64_tr_b16 v[108:109], v4 offset:49152
    v_mfma_f32_16x16x32_bf16 v[40:43], v[88:91], v[228:231], v[40:43]
    ds_read_b64_tr_b16 v[110:111], v4 offset:51200
    v_mfma_f32_16x16x32_bf16 v[44:47], v[92:95], v[228:231], v[44:47]
    ds_read_b64_tr_b16 v[112:113], v5 offset:49152
    v_mfma_f32_16x16x32_bf16 v[48:51], v[96:99], v[228:231], v[48:51]
    ds_read_b64_tr_b16 v[114:115], v5 offset:51200
    s_add_u32 s0, s0, 57344
    buffer_load_dwordx4 v[228:231], v251, s[56:59], s0 offen offset:0
    v_mfma_f32_16x16x32_bf16 v[52:55], v[84:87], v[232:235], v[52:55]
    v_mfma_f32_16x16x32_bf16 v[56:59], v[88:91], v[232:235], v[56:59]
    v_mfma_f32_16x16x32_bf16 v[60:63], v[92:95], v[232:235], v[60:63]
    v_mfma_f32_16x16x32_bf16 v[64:67], v[96:99], v[232:235], v[64:67]
    s_add_u32 s0, s0, 57344
    buffer_load_dwordx4 v[232:235], v251, s[56:59], s0 offen offset:0
    v_mfma_f32_16x16x32_bf16 v[68:71], v[84:87], v[236:239], v[68:71]
    v_mfma_f32_16x16x32_bf16 v[72:75], v[88:91], v[236:239], v[72:75]
    v_mfma_f32_16x16x32_bf16 v[76:79], v[92:95], v[236:239], v[76:79]
    v_mfma_f32_16x16x32_bf16 v[80:83], v[96:99], v[236:239], v[80:83]
    s_add_u32 s0, s0, 57344
    buffer_load_dwordx4 v[236:239], v251, s[56:59], s0 offen offset:0
    s_waitcnt lgkmcnt(0)
    s_barrier
    s_waitcnt vmcnt(32)
    s_xor_b32 s0, s1, 1
    s_mul_i32 s0, s0, 7168
    s_add_u32 s0, s0, 3584
    v_mfma_f32_16x16x32_bf16 v[20:23], v[100:103], v[116:119], v[20:23]
    ds_read_b64_tr_b16 v[84:85], v6 offset:0
    v_mfma_f32_16x16x32_bf16 v[24:27], v[104:107], v[116:119], v[24:27]
    ds_read_b64_tr_b16 v[86:87], v6 offset:2048
    v_mfma_f32_16x16x32_bf16 v[28:31], v[108:111], v[116:119], v[28:31]
    ds_read_b64_tr_b16 v[88:89], v7 offset:0
    v_mfma_f32_16x16x32_bf16 v[32:35], v[112:115], v[116:119], v[32:35]
    ds_read_b64_tr_b16 v[90:91], v7 offset:2048
    buffer_load_dwordx4 v[116:119], v251, s[56:59], s0 offen offset:1024
    v_mfma_f32_16x16x32_bf16 v[36:39], v[100:103], v[120:123], v[36:39]
    ds_read_b64_tr_b16 v[92:93], v8 offset:0
    v_mfma_f32_16x16x32_bf16 v[40:43], v[104:107], v[120:123], v[40:43]
    ds_read_b64_tr_b16 v[94:95], v8 offset:2048
    v_mfma_f32_16x16x32_bf16 v[44:47], v[108:111], v[120:123], v[44:47]
    ds_read_b64_tr_b16 v[96:97], v9 offset:0
    v_mfma_f32_16x16x32_bf16 v[48:51], v[112:115], v[120:123], v[48:51]
    ds_read_b64_tr_b16 v[98:99], v9 offset:2048
    s_add_u32 s0, s0, 57344
    buffer_load_dwordx4 v[120:123], v251, s[56:59], s0 offen offset:1024
    v_mfma_f32_16x16x32_bf16 v[52:55], v[100:103], v[124:127], v[52:55]
    v_mfma_f32_16x16x32_bf16 v[56:59], v[104:107], v[124:127], v[56:59]
    v_mfma_f32_16x16x32_bf16 v[60:63], v[108:111], v[124:127], v[60:63]
    v_mfma_f32_16x16x32_bf16 v[64:67], v[112:115], v[124:127], v[64:67]
    s_add_u32 s0, s0, 57344
    buffer_load_dwordx4 v[124:127], v251, s[56:59], s0 offen offset:1024
    v_mfma_f32_16x16x32_bf16 v[68:71], v[100:103], v[128:131], v[68:71]
    v_mfma_f32_16x16x32_bf16 v[72:75], v[104:107], v[128:131], v[72:75]
    v_mfma_f32_16x16x32_bf16 v[76:79], v[108:111], v[128:131], v[76:79]
    v_mfma_f32_16x16x32_bf16 v[80:83], v[112:115], v[128:131], v[80:83]
    s_add_u32 s0, s0, 57344
    buffer_load_dwordx4 v[128:131], v251, s[56:59], s0 offen offset:1024
    s_waitcnt lgkmcnt(0)
    s_barrier
    s_waitcnt vmcnt(32)
    s_xor_b32 s0, s1, 1
    s_mul_i32 s0, s0, 7168
    s_add_u32 s0, s0, 3584
    v_mfma_f32_16x16x32_bf16 v[20:23], v[84:87], v[132:135], v[20:23]
    ds_read_b64_tr_b16 v[100:101], v6 offset:16384
    v_mfma_f32_16x16x32_bf16 v[24:27], v[88:91], v[132:135], v[24:27]
    ds_read_b64_tr_b16 v[102:103], v6 offset:18432
    v_mfma_f32_16x16x32_bf16 v[28:31], v[92:95], v[132:135], v[28:31]
    ds_read_b64_tr_b16 v[104:105], v7 offset:16384
    v_mfma_f32_16x16x32_bf16 v[32:35], v[96:99], v[132:135], v[32:35]
    ds_read_b64_tr_b16 v[106:107], v7 offset:18432
    buffer_load_dwordx4 v[132:135], v251, s[56:59], s0 offen offset:2048
    v_mfma_f32_16x16x32_bf16 v[36:39], v[84:87], v[136:139], v[36:39]
    ds_read_b64_tr_b16 v[108:109], v8 offset:16384
    v_mfma_f32_16x16x32_bf16 v[40:43], v[88:91], v[136:139], v[40:43]
    ds_read_b64_tr_b16 v[110:111], v8 offset:18432
    v_mfma_f32_16x16x32_bf16 v[44:47], v[92:95], v[136:139], v[44:47]
    ds_read_b64_tr_b16 v[112:113], v9 offset:16384
    v_mfma_f32_16x16x32_bf16 v[48:51], v[96:99], v[136:139], v[48:51]
    ds_read_b64_tr_b16 v[114:115], v9 offset:18432
    s_add_u32 s0, s0, 57344
    buffer_load_dwordx4 v[136:139], v251, s[56:59], s0 offen offset:2048
    v_mfma_f32_16x16x32_bf16 v[52:55], v[84:87], v[140:143], v[52:55]
    v_mfma_f32_16x16x32_bf16 v[56:59], v[88:91], v[140:143], v[56:59]
    v_mfma_f32_16x16x32_bf16 v[60:63], v[92:95], v[140:143], v[60:63]
    v_mfma_f32_16x16x32_bf16 v[64:67], v[96:99], v[140:143], v[64:67]
    s_add_u32 s0, s0, 57344
    buffer_load_dwordx4 v[140:143], v251, s[56:59], s0 offen offset:2048
    v_mfma_f32_16x16x32_bf16 v[68:71], v[84:87], v[144:147], v[68:71]
    v_mfma_f32_16x16x32_bf16 v[72:75], v[88:91], v[144:147], v[72:75]
    v_mfma_f32_16x16x32_bf16 v[76:79], v[92:95], v[144:147], v[76:79]
    v_mfma_f32_16x16x32_bf16 v[80:83], v[96:99], v[144:147], v[80:83]
    s_add_u32 s0, s0, 57344
    buffer_load_dwordx4 v[144:147], v251, s[56:59], s0 offen offset:2048
    s_waitcnt lgkmcnt(0)
    s_barrier
    s_waitcnt vmcnt(32)
    s_xor_b32 s0, s1, 1
    s_mul_i32 s0, s0, 7168
    v_mfma_f32_16x16x32_bf16 v[20:23], v[100:103], v[176:179], v[20:23]
    ds_read_b64_tr_b16 v[84:85], v246 offset:0
    v_mfma_f32_16x16x32_bf16 v[24:27], v[104:107], v[176:179], v[24:27]
    ds_read_b64_tr_b16 v[86:87], v246 offset:2048
    v_mfma_f32_16x16x32_bf16 v[28:31], v[108:111], v[176:179], v[28:31]
    ds_read_b64_tr_b16 v[88:89], v247 offset:0
    v_mfma_f32_16x16x32_bf16 v[32:35], v[112:115], v[176:179], v[32:35]
    ds_read_b64_tr_b16 v[90:91], v247 offset:2048
    buffer_load_dwordx2 v[176:177], v252, s[56:59], s0 offen
    buffer_load_dwordx2 v[178:179], v252, s[56:59], s0 offen offset:3584
    v_mfma_f32_16x16x32_bf16 v[36:39], v[100:103], v[180:183], v[36:39]
    ds_read_b64_tr_b16 v[92:93], v248 offset:0
    v_mfma_f32_16x16x32_bf16 v[40:43], v[104:107], v[180:183], v[40:43]
    ds_read_b64_tr_b16 v[94:95], v248 offset:2048
    v_mfma_f32_16x16x32_bf16 v[44:47], v[108:111], v[180:183], v[44:47]
    ds_read_b64_tr_b16 v[96:97], v249 offset:0
    v_mfma_f32_16x16x32_bf16 v[48:51], v[112:115], v[180:183], v[48:51]
    ds_read_b64_tr_b16 v[98:99], v249 offset:2048
    s_add_u32 s0, s0, 57344
    buffer_load_dwordx2 v[180:181], v252, s[56:59], s0 offen
    buffer_load_dwordx2 v[182:183], v252, s[56:59], s0 offen offset:3584
    v_mfma_f32_16x16x32_bf16 v[52:55], v[100:103], v[184:187], v[52:55]
    v_mfma_f32_16x16x32_bf16 v[56:59], v[104:107], v[184:187], v[56:59]
    v_mfma_f32_16x16x32_bf16 v[60:63], v[108:111], v[184:187], v[60:63]
    v_mfma_f32_16x16x32_bf16 v[64:67], v[112:115], v[184:187], v[64:67]
    s_add_u32 s0, s0, 57344
    buffer_load_dwordx2 v[184:185], v252, s[56:59], s0 offen
    buffer_load_dwordx2 v[186:187], v252, s[56:59], s0 offen offset:3584
    v_mfma_f32_16x16x32_bf16 v[68:71], v[100:103], v[188:191], v[68:71]
    v_mfma_f32_16x16x32_bf16 v[72:75], v[104:107], v[188:191], v[72:75]
    v_mfma_f32_16x16x32_bf16 v[76:79], v[108:111], v[188:191], v[76:79]
    v_mfma_f32_16x16x32_bf16 v[80:83], v[112:115], v[188:191], v[80:83]
    s_add_u32 s0, s0, 57344
    buffer_load_dwordx2 v[188:189], v252, s[56:59], s0 offen
    buffer_load_dwordx2 v[190:191], v252, s[56:59], s0 offen offset:3584
    s_waitcnt lgkmcnt(0)
    s_barrier
    s_waitcnt vmcnt(32)
    v_mfma_f32_16x16x32_bf16 v[20:23], v[84:87], v[192:195], v[20:23]
    ds_read_b64_tr_b16 v[100:101], v2 offset:0
    v_mfma_f32_16x16x32_bf16 v[24:27], v[88:91], v[192:195], v[24:27]
    ds_read_b64_tr_b16 v[102:103], v2 offset:2048
    v_mfma_f32_16x16x32_bf16 v[28:31], v[92:95], v[192:195], v[28:31]
    ds_read_b64_tr_b16 v[104:105], v3 offset:0
    v_mfma_f32_16x16x32_bf16 v[32:35], v[96:99], v[192:195], v[32:35]
    ds_read_b64_tr_b16 v[106:107], v3 offset:2048
    v_mfma_f32_16x16x32_bf16 v[36:39], v[84:87], v[196:199], v[36:39]
    ds_read_b64_tr_b16 v[108:109], v4 offset:0
    v_mfma_f32_16x16x32_bf16 v[40:43], v[88:91], v[196:199], v[40:43]
    ds_read_b64_tr_b16 v[110:111], v4 offset:2048
    v_mfma_f32_16x16x32_bf16 v[44:47], v[92:95], v[196:199], v[44:47]
    ds_read_b64_tr_b16 v[112:113], v5 offset:0
    v_mfma_f32_16x16x32_bf16 v[48:51], v[96:99], v[196:199], v[48:51]
    ds_read_b64_tr_b16 v[114:115], v5 offset:2048
    v_mfma_f32_16x16x32_bf16 v[52:55], v[84:87], v[200:203], v[52:55]
    v_mfma_f32_16x16x32_bf16 v[56:59], v[88:91], v[200:203], v[56:59]
    v_mfma_f32_16x16x32_bf16 v[60:63], v[92:95], v[200:203], v[60:63]
    v_mfma_f32_16x16x32_bf16 v[64:67], v[96:99], v[200:203], v[64:67]
    v_mfma_f32_16x16x32_bf16 v[68:71], v[84:87], v[204:207], v[68:71]
    v_mfma_f32_16x16x32_bf16 v[72:75], v[88:91], v[204:207], v[72:75]
    v_mfma_f32_16x16x32_bf16 v[76:79], v[92:95], v[204:207], v[76:79]
    v_mfma_f32_16x16x32_bf16 v[80:83], v[96:99], v[204:207], v[80:83]
    s_waitcnt lgkmcnt(0)
    s_barrier
    s_waitcnt vmcnt(24)
    v_mfma_f32_16x16x32_bf16 v[20:23], v[100:103], v[208:211], v[20:23]
    ds_read_b64_tr_b16 v[84:85], v2 offset:16384
    v_mfma_f32_16x16x32_bf16 v[24:27], v[104:107], v[208:211], v[24:27]
    ds_read_b64_tr_b16 v[86:87], v2 offset:18432
    v_mfma_f32_16x16x32_bf16 v[28:31], v[108:111], v[208:211], v[28:31]
    ds_read_b64_tr_b16 v[88:89], v3 offset:16384
    v_mfma_f32_16x16x32_bf16 v[32:35], v[112:115], v[208:211], v[32:35]
    ds_read_b64_tr_b16 v[90:91], v3 offset:18432
    v_mfma_f32_16x16x32_bf16 v[36:39], v[100:103], v[212:215], v[36:39]
    ds_read_b64_tr_b16 v[92:93], v4 offset:16384
    v_mfma_f32_16x16x32_bf16 v[40:43], v[104:107], v[212:215], v[40:43]
    ds_read_b64_tr_b16 v[94:95], v4 offset:18432
    v_mfma_f32_16x16x32_bf16 v[44:47], v[108:111], v[212:215], v[44:47]
    ds_read_b64_tr_b16 v[96:97], v5 offset:16384
    v_mfma_f32_16x16x32_bf16 v[48:51], v[112:115], v[212:215], v[48:51]
    ds_read_b64_tr_b16 v[98:99], v5 offset:18432
    v_mfma_f32_16x16x32_bf16 v[52:55], v[100:103], v[216:219], v[52:55]
    v_mfma_f32_16x16x32_bf16 v[56:59], v[104:107], v[216:219], v[56:59]
    v_mfma_f32_16x16x32_bf16 v[60:63], v[108:111], v[216:219], v[60:63]
    v_mfma_f32_16x16x32_bf16 v[64:67], v[112:115], v[216:219], v[64:67]
    v_mfma_f32_16x16x32_bf16 v[68:71], v[100:103], v[240:243], v[68:71]
    v_mfma_f32_16x16x32_bf16 v[72:75], v[104:107], v[240:243], v[72:75]
    v_mfma_f32_16x16x32_bf16 v[76:79], v[108:111], v[240:243], v[76:79]
    v_mfma_f32_16x16x32_bf16 v[80:83], v[112:115], v[240:243], v[80:83]
    s_waitcnt lgkmcnt(0)
    s_barrier
    v_mfma_f32_16x16x32_bf16 v[20:23], v[84:87], v[148:151], v[20:23]
    ds_read_b64_tr_b16 v[100:101], v2 offset:32768
    v_mfma_f32_16x16x32_bf16 v[24:27], v[88:91], v[148:151], v[24:27]
    ds_read_b64_tr_b16 v[102:103], v2 offset:34816
    v_mfma_f32_16x16x32_bf16 v[28:31], v[92:95], v[148:151], v[28:31]
    ds_read_b64_tr_b16 v[104:105], v3 offset:32768
    v_mfma_f32_16x16x32_bf16 v[32:35], v[96:99], v[148:151], v[32:35]
    ds_read_b64_tr_b16 v[106:107], v3 offset:34816
    v_mfma_f32_16x16x32_bf16 v[36:39], v[84:87], v[152:155], v[36:39]
    ds_read_b64_tr_b16 v[108:109], v4 offset:32768
    v_mfma_f32_16x16x32_bf16 v[40:43], v[88:91], v[152:155], v[40:43]
    ds_read_b64_tr_b16 v[110:111], v4 offset:34816
    v_mfma_f32_16x16x32_bf16 v[44:47], v[92:95], v[152:155], v[44:47]
    ds_read_b64_tr_b16 v[112:113], v5 offset:32768
    v_mfma_f32_16x16x32_bf16 v[48:51], v[96:99], v[152:155], v[48:51]
    ds_read_b64_tr_b16 v[114:115], v5 offset:34816
    v_mfma_f32_16x16x32_bf16 v[52:55], v[84:87], v[156:159], v[52:55]
    v_mfma_f32_16x16x32_bf16 v[56:59], v[88:91], v[156:159], v[56:59]
    v_mfma_f32_16x16x32_bf16 v[60:63], v[92:95], v[156:159], v[60:63]
    v_mfma_f32_16x16x32_bf16 v[64:67], v[96:99], v[156:159], v[64:67]
    v_mfma_f32_16x16x32_bf16 v[68:71], v[84:87], v[160:163], v[68:71]
    v_mfma_f32_16x16x32_bf16 v[72:75], v[88:91], v[160:163], v[72:75]
    v_mfma_f32_16x16x32_bf16 v[76:79], v[92:95], v[160:163], v[76:79]
    v_mfma_f32_16x16x32_bf16 v[80:83], v[96:99], v[160:163], v[80:83]
    s_waitcnt lgkmcnt(0)
    s_barrier
    s_waitcnt vmcnt(20)
    v_mfma_f32_16x16x32_bf16 v[20:23], v[100:103], v[164:167], v[20:23]
    ds_read_b64_tr_b16 v[84:85], v2 offset:49152
    v_mfma_f32_16x16x32_bf16 v[24:27], v[104:107], v[164:167], v[24:27]
    ds_read_b64_tr_b16 v[86:87], v2 offset:51200
    v_mfma_f32_16x16x32_bf16 v[28:31], v[108:111], v[164:167], v[28:31]
    ds_read_b64_tr_b16 v[88:89], v3 offset:49152
    v_mfma_f32_16x16x32_bf16 v[32:35], v[112:115], v[164:167], v[32:35]
    ds_read_b64_tr_b16 v[90:91], v3 offset:51200
    v_mfma_f32_16x16x32_bf16 v[36:39], v[100:103], v[168:171], v[36:39]
    ds_read_b64_tr_b16 v[92:93], v4 offset:49152
    v_mfma_f32_16x16x32_bf16 v[40:43], v[104:107], v[168:171], v[40:43]
    ds_read_b64_tr_b16 v[94:95], v4 offset:51200
    v_mfma_f32_16x16x32_bf16 v[44:47], v[108:111], v[168:171], v[44:47]
    ds_read_b64_tr_b16 v[96:97], v5 offset:49152
    v_mfma_f32_16x16x32_bf16 v[48:51], v[112:115], v[168:171], v[48:51]
    ds_read_b64_tr_b16 v[98:99], v5 offset:51200
    v_mfma_f32_16x16x32_bf16 v[52:55], v[100:103], v[172:175], v[52:55]
    v_mfma_f32_16x16x32_bf16 v[56:59], v[104:107], v[172:175], v[56:59]
    v_mfma_f32_16x16x32_bf16 v[60:63], v[108:111], v[172:175], v[60:63]
    v_mfma_f32_16x16x32_bf16 v[64:67], v[112:115], v[172:175], v[64:67]
    v_mfma_f32_16x16x32_bf16 v[68:71], v[100:103], v[220:223], v[68:71]
    v_mfma_f32_16x16x32_bf16 v[72:75], v[104:107], v[220:223], v[72:75]
    v_mfma_f32_16x16x32_bf16 v[76:79], v[108:111], v[220:223], v[76:79]
    v_mfma_f32_16x16x32_bf16 v[80:83], v[112:115], v[220:223], v[80:83]
    s_waitcnt lgkmcnt(0)
    s_barrier
    s_waitcnt vmcnt(16)
    s_lshl_b32 s92, s88, 6
    s_lshl_b32 s93, s84, 4
    s_add_u32 s92, s92, s93
    v_add_u32 v19, s92, v10
    v_lshlrev_b32 v12, 2, v19
    s_add_u32 s76, s38, 12582912
    s_addc_u32 s77, s39, 0
    s_mov_b32 s78, 8192
    s_mov_b32 s79, 0x20000
    buffer_load_dword v18, v12, s[76:79], 0 offen sc1
    s_mov_b32 s80, s30
    s_mov_b32 s81, s31
    s_mov_b32 s82, 1024
    s_mov_b32 s83, 0x20000
    buffer_load_dwordx2 v[192:193], v17, s[80:83], 0 offen offset:0
    buffer_load_dwordx2 v[194:195], v17, s[80:83], 0 offen offset:32
    buffer_load_dwordx2 v[196:197], v17, s[80:83], 0 offen offset:64
    buffer_load_dwordx2 v[198:199], v17, s[80:83], 0 offen offset:96
    v_mfma_f32_16x16x32_bf16 v[20:23], v[84:87], v[224:227], v[20:23]
    ds_read_b64_tr_b16 v[100:101], v6 offset:0
    v_mfma_f32_16x16x32_bf16 v[24:27], v[88:91], v[224:227], v[24:27]
    ds_read_b64_tr_b16 v[102:103], v6 offset:2048
    v_mfma_f32_16x16x32_bf16 v[28:31], v[92:95], v[224:227], v[28:31]
    ds_read_b64_tr_b16 v[104:105], v7 offset:0
    v_mfma_f32_16x16x32_bf16 v[32:35], v[96:99], v[224:227], v[32:35]
    ds_read_b64_tr_b16 v[106:107], v7 offset:2048
    v_mfma_f32_16x16x32_bf16 v[36:39], v[84:87], v[228:231], v[36:39]
    ds_read_b64_tr_b16 v[108:109], v8 offset:0
    v_mfma_f32_16x16x32_bf16 v[40:43], v[88:91], v[228:231], v[40:43]
    ds_read_b64_tr_b16 v[110:111], v8 offset:2048
    v_mfma_f32_16x16x32_bf16 v[44:47], v[92:95], v[228:231], v[44:47]
    ds_read_b64_tr_b16 v[112:113], v9 offset:0
    v_mfma_f32_16x16x32_bf16 v[48:51], v[96:99], v[228:231], v[48:51]
    ds_read_b64_tr_b16 v[114:115], v9 offset:2048
    v_mfma_f32_16x16x32_bf16 v[52:55], v[84:87], v[232:235], v[52:55]
    v_mfma_f32_16x16x32_bf16 v[56:59], v[88:91], v[232:235], v[56:59]
    v_mfma_f32_16x16x32_bf16 v[60:63], v[92:95], v[232:235], v[60:63]
    v_mfma_f32_16x16x32_bf16 v[64:67], v[96:99], v[232:235], v[64:67]
    v_mfma_f32_16x16x32_bf16 v[68:71], v[84:87], v[236:239], v[68:71]
    v_mfma_f32_16x16x32_bf16 v[72:75], v[88:91], v[236:239], v[72:75]
    v_mfma_f32_16x16x32_bf16 v[76:79], v[92:95], v[236:239], v[76:79]
    v_mfma_f32_16x16x32_bf16 v[80:83], v[96:99], v[236:239], v[80:83]
    s_waitcnt lgkmcnt(0)
    s_barrier
    s_waitcnt vmcnt(17)
    v_mfma_f32_16x16x32_bf16 v[20:23], v[100:103], v[116:119], v[20:23]
    ds_read_b64_tr_b16 v[84:85], v6 offset:16384
    v_mfma_f32_16x16x32_bf16 v[24:27], v[104:107], v[116:119], v[24:27]
    ds_read_b64_tr_b16 v[86:87], v6 offset:18432
    v_mfma_f32_16x16x32_bf16 v[28:31], v[108:111], v[116:119], v[28:31]
    ds_read_b64_tr_b16 v[88:89], v7 offset:16384
    v_mfma_f32_16x16x32_bf16 v[32:35], v[112:115], v[116:119], v[32:35]
    ds_read_b64_tr_b16 v[90:91], v7 offset:18432
    v_mfma_f32_16x16x32_bf16 v[36:39], v[100:103], v[120:123], v[36:39]
    ds_read_b64_tr_b16 v[92:93], v8 offset:16384
    v_mfma_f32_16x16x32_bf16 v[40:43], v[104:107], v[120:123], v[40:43]
    ds_read_b64_tr_b16 v[94:95], v8 offset:18432
    v_mfma_f32_16x16x32_bf16 v[44:47], v[108:111], v[120:123], v[44:47]
    ds_read_b64_tr_b16 v[96:97], v9 offset:16384
    v_mfma_f32_16x16x32_bf16 v[48:51], v[112:115], v[120:123], v[48:51]
    ds_read_b64_tr_b16 v[98:99], v9 offset:18432
    v_mfma_f32_16x16x32_bf16 v[52:55], v[100:103], v[124:127], v[52:55]
    v_mfma_f32_16x16x32_bf16 v[56:59], v[104:107], v[124:127], v[56:59]
    v_mfma_f32_16x16x32_bf16 v[60:63], v[108:111], v[124:127], v[60:63]
    v_mfma_f32_16x16x32_bf16 v[64:67], v[112:115], v[124:127], v[64:67]
    v_mfma_f32_16x16x32_bf16 v[68:71], v[100:103], v[128:131], v[68:71]
    v_mfma_f32_16x16x32_bf16 v[72:75], v[104:107], v[128:131], v[72:75]
    v_mfma_f32_16x16x32_bf16 v[76:79], v[108:111], v[128:131], v[76:79]
    v_mfma_f32_16x16x32_bf16 v[80:83], v[112:115], v[128:131], v[80:83]
    s_waitcnt lgkmcnt(0)
    s_barrier
    s_waitcnt vmcnt(13)
    v_mfma_f32_16x16x32_bf16 v[20:23], v[84:87], v[132:135], v[20:23]
    ds_read_b64_tr_b16 v[100:101], v246 offset:0
    v_mfma_f32_16x16x32_bf16 v[24:27], v[88:91], v[132:135], v[24:27]
    ds_read_b64_tr_b16 v[102:103], v246 offset:2048
    v_mfma_f32_16x16x32_bf16 v[28:31], v[92:95], v[132:135], v[28:31]
    ds_read_b64_tr_b16 v[104:105], v247 offset:0
    v_mfma_f32_16x16x32_bf16 v[32:35], v[96:99], v[132:135], v[32:35]
    ds_read_b64_tr_b16 v[106:107], v247 offset:2048
    v_mfma_f32_16x16x32_bf16 v[36:39], v[84:87], v[136:139], v[36:39]
    ds_read_b64_tr_b16 v[108:109], v248 offset:0
    v_mfma_f32_16x16x32_bf16 v[40:43], v[88:91], v[136:139], v[40:43]
    ds_read_b64_tr_b16 v[110:111], v248 offset:2048
    v_mfma_f32_16x16x32_bf16 v[44:47], v[92:95], v[136:139], v[44:47]
    ds_read_b64_tr_b16 v[112:113], v249 offset:0
    v_mfma_f32_16x16x32_bf16 v[48:51], v[96:99], v[136:139], v[48:51]
    ds_read_b64_tr_b16 v[114:115], v249 offset:2048
    v_mfma_f32_16x16x32_bf16 v[52:55], v[84:87], v[140:143], v[52:55]
    v_mfma_f32_16x16x32_bf16 v[56:59], v[88:91], v[140:143], v[56:59]
    v_mfma_f32_16x16x32_bf16 v[60:63], v[92:95], v[140:143], v[60:63]
    v_mfma_f32_16x16x32_bf16 v[64:67], v[96:99], v[140:143], v[64:67]
    v_mfma_f32_16x16x32_bf16 v[68:71], v[84:87], v[144:147], v[68:71]
    v_mfma_f32_16x16x32_bf16 v[72:75], v[88:91], v[144:147], v[72:75]
    v_mfma_f32_16x16x32_bf16 v[76:79], v[92:95], v[144:147], v[76:79]
    v_mfma_f32_16x16x32_bf16 v[80:83], v[96:99], v[144:147], v[80:83]
    s_waitcnt lgkmcnt(0)
    s_waitcnt vmcnt(5)
    v_mfma_f32_16x16x32_bf16 v[20:23], v[100:103], v[176:179], v[20:23]
    v_mfma_f32_16x16x32_bf16 v[24:27], v[104:107], v[176:179], v[24:27]
    v_mfma_f32_16x16x32_bf16 v[28:31], v[108:111], v[176:179], v[28:31]
    v_mfma_f32_16x16x32_bf16 v[32:35], v[112:115], v[176:179], v[32:35]
    v_mfma_f32_16x16x32_bf16 v[36:39], v[100:103], v[180:183], v[36:39]
    v_mfma_f32_16x16x32_bf16 v[40:43], v[104:107], v[180:183], v[40:43]
    v_mfma_f32_16x16x32_bf16 v[44:47], v[108:111], v[180:183], v[44:47]
    v_mfma_f32_16x16x32_bf16 v[48:51], v[112:115], v[180:183], v[48:51]
    v_mfma_f32_16x16x32_bf16 v[52:55], v[100:103], v[184:187], v[52:55]
    v_mfma_f32_16x16x32_bf16 v[56:59], v[104:107], v[184:187], v[56:59]
    v_mfma_f32_16x16x32_bf16 v[60:63], v[108:111], v[184:187], v[60:63]
    v_mfma_f32_16x16x32_bf16 v[64:67], v[112:115], v[184:187], v[64:67]
    v_mfma_f32_16x16x32_bf16 v[68:71], v[100:103], v[188:191], v[68:71]
    v_mfma_f32_16x16x32_bf16 v[72:75], v[104:107], v[188:191], v[72:75]
    v_mfma_f32_16x16x32_bf16 v[76:79], v[108:111], v[188:191], v[76:79]
    v_mfma_f32_16x16x32_bf16 v[80:83], v[112:115], v[188:191], v[80:83]
    s_lshl_b32 s95, s84, 14
    v_lshlrev_b32 v12, 4, v1
    v_add_u32 v13, s95, v12
    s_nop 4
    s_cmp_lg_u32 s84, 0
    s_cbranch_scc1 red_23
    ds_write_b128 v13, v[36:39] offset:4096
    ds_write_b128 v13, v[40:43] offset:5120
    ds_write_b128 v13, v[44:47] offset:6144
    ds_write_b128 v13, v[48:51] offset:7168
    ds_write_b128 v13, v[52:55] offset:8192
    ds_write_b128 v13, v[56:59] offset:9216
    ds_write_b128 v13, v[60:63] offset:10240
    ds_write_b128 v13, v[64:67] offset:11264
    ds_write_b128 v13, v[68:71] offset:12288
    ds_write_b128 v13, v[72:75] offset:13312
    ds_write_b128 v13, v[76:79] offset:14336
    ds_write_b128 v13, v[80:83] offset:15360
    s_branch redj_26
red_23:
    s_cmp_lg_u32 s84, 1
    s_cbranch_scc1 red_24
    ds_write_b128 v13, v[20:23] offset:0
    ds_write_b128 v13, v[24:27] offset:1024
    ds_write_b128 v13, v[28:31] offset:2048
    ds_write_b128 v13, v[32:35] offset:3072
    ds_write_b128 v13, v[52:55] offset:8192
    ds_write_b128 v13, v[56:59] offset:9216
    ds_write_b128 v13, v[60:63] offset:10240
    ds_write_b128 v13, v[64:67] offset:11264
    ds_write_b128 v13, v[68:71] offset:12288
    ds_write_b128 v13, v[72:75] offset:13312
    ds_write_b128 v13, v[76:79] offset:14336
    ds_write_b128 v13, v[80:83] offset:15360
    s_nop 1
    v_mov_b32 v20, v36
    v_mov_b32 v21, v37
    v_mov_b32 v22, v38
    v_mov_b32 v23, v39
    v_mov_b32 v24, v40
    v_mov_b32 v25, v41
    v_mov_b32 v26, v42
    v_mov_b32 v27, v43
    v_mov_b32 v28, v44
    v_mov_b32 v29, v45
    v_mov_b32 v30, v46
    v_mov_b32 v31, v47
    v_mov_b32 v32, v48
    v_mov_b32 v33, v49
    v_mov_b32 v34, v50
    v_mov_b32 v35, v51
    s_branch redj_26
red_24:
    s_cmp_lg_u32 s84, 2
    s_cbranch_scc1 red_25
    ds_write_b128 v13, v[20:23] offset:0
    ds_write_b128 v13, v[24:27] offset:1024
    ds_write_b128 v13, v[28:31] offset:2048
    ds_write_b128 v13, v[32:35] offset:3072
    ds_write_b128 v13, v[36:39] offset:4096
    ds_write_b128 v13, v[40:43] offset:5120
    ds_write_b128 v13, v[44:47] offset:6144
    ds_write_b128 v13, v[48:51] offset:7168
    ds_write_b128 v13, v[68:71] offset:12288
    ds_write_b128 v13, v[72:75] offset:13312
    ds_write_b128 v13, v[76:79] offset:14336
    ds_write_b128 v13, v[80:83] offset:15360
    s_nop 1
    v_mov_b32 v20, v52
    v_mov_b32 v21, v53
    v_mov_b32 v22, v54
    v_mov_b32 v23, v55
    v_mov_b32 v24, v56
    v_mov_b32 v25, v57
    v_mov_b32 v26, v58
    v_mov_b32 v27, v59
    v_mov_b32 v28, v60
    v_mov_b32 v29, v61
    v_mov_b32 v30, v62
    v_mov_b32 v31, v63
    v_mov_b32 v32, v64
    v_mov_b32 v33, v65
    v_mov_b32 v34, v66
    v_mov_b32 v35, v67
    s_branch redj_26
red_25:
    ds_write_b128 v13, v[20:23] offset:0
    ds_write_b128 v13, v[24:27] offset:1024
    ds_write_b128 v13, v[28:31] offset:2048
    ds_write_b128 v13, v[32:35] offset:3072
    ds_write_b128 v13, v[36:39] offset:4096
    ds_write_b128 v13, v[40:43] offset:5120
    ds_write_b128 v13, v[44:47] offset:6144
    ds_write_b128 v13, v[48:51] offset:7168
    ds_write_b128 v13, v[52:55] offset:8192
    ds_write_b128 v13, v[56:59] offset:9216
    ds_write_b128 v13, v[60:63] offset:10240
    ds_write_b128 v13, v[64:67] offset:11264
    s_nop 1
    v_mov_b32 v20, v68
    v_mov_b32 v21, v69
    v_mov_b32 v22, v70
    v_mov_b32 v23, v71
    v_mov_b32 v24, v72
    v_mov_b32 v25, v73
    v_mov_b32 v26, v74
    v_mov_b32 v27, v75
    v_mov_b32 v28, v76
    v_mov_b32 v29, v77
    v_mov_b32 v30, v78
    v_mov_b32 v31, v79
    v_mov_b32 v32, v80
    v_mov_b32 v33, v81
    v_mov_b32 v34, v82
    v_mov_b32 v35, v83
redj_26:
    s_waitcnt lgkmcnt(0)
    s_barrier
    s_lshl_b32 s92, s84, 12
    v_add_u32 v12, s92, v12
    s_add_u32 s92, s84, 1
    s_and_b32 s92, s92, 3
    s_lshl_b32 s92, s92, 14
    v_add_u32 v13, s92, v12
    ds_read_b128 v[36:39], v13 offset:0
    ds_read_b128 v[40:43], v13 offset:1024
    ds_read_b128 v[44:47], v13 offset:2048
    ds_read_b128 v[48:51], v13 offset:3072
    s_add_u32 s92, s84, 2
    s_and_b32 s92, s92, 3
    s_lshl_b32 s92, s92, 14
    v_add_u32 v13, s92, v12
    ds_read_b128 v[52:55], v13 offset:0
    ds_read_b128 v[56:59], v13 offset:1024
    ds_read_b128 v[60:63], v13 offset:2048
    ds_read_b128 v[64:67], v13 offset:3072
    s_add_u32 s92, s84, 3
    s_and_b32 s92, s92, 3
    s_lshl_b32 s92, s92, 14
    v_add_u32 v13, s92, v12
    ds_read_b128 v[68:71], v13 offset:0
    ds_read_b128 v[72:75], v13 offset:1024
    ds_read_b128 v[76:79], v13 offset:2048
    ds_read_b128 v[80:83], v13 offset:3072
    v_lshrrev_b32 v12, 2, v1
    v_lshlrev_b32 v12, 7, v12
    v_and_b32 v13, 3, v1
    v_lshl_add_u32 v12, v13, 3, v12
    s_lshl_b32 s92, s84, 5
    s_add_u32 s92, s92, 147456
    v_add_u32 v12, s92, v12
    ds_read_b64_tr_b16 v[84:85], v12 offset:0
    ds_read_b64_tr_b16 v[86:87], v12 offset:2048
    ds_read_b64_tr_b16 v[88:89], v12 offset:4096
    ds_read_b64_tr_b16 v[90:91], v12 offset:6144
    s_waitcnt vmcnt(0)
    v_sub_f32 v92, 1.0, v18
    v_cvt_pk_bf16_f32 v92, v92, v92
    v_lshlrev_b32 v92, 16, v92
    v_lshlrev_b32 v93, 10, v19
    v_add_u32 v93, v93, v17
    s_mov_b32 s92, 0xffff0000
    s_waitcnt lgkmcnt(0)
    v_pk_add_f32 v[20:21], v[20:21], v[36:37]
    v_pk_add_f32 v[22:23], v[22:23], v[38:39]
    v_pk_add_f32 v[20:21], v[20:21], v[52:53]
    v_pk_add_f32 v[22:23], v[22:23], v[54:55]
    v_pk_add_f32 v[20:21], v[20:21], v[68:69]
    v_pk_add_f32 v[22:23], v[22:23], v[70:71]
    v_lshlrev_b32 v100, 16, v192
    v_and_b32 v101, s92, v192
    v_lshlrev_b32 v102, 16, v193
    v_and_b32 v103, s92, v193
    v_lshlrev_b32 v96, 16, v84
    v_and_b32 v97, s92, v84
    v_lshlrev_b32 v98, 16, v85
    v_and_b32 v99, s92, v85
    v_pk_add_f32 v[20:21], v[20:21], v[100:101]
    v_pk_add_f32 v[22:23], v[22:23], v[102:103]
    v_mul_f32 v96, v96, v18
    v_mul_f32 v97, v97, v18
    v_mul_f32 v98, v98, v18
    v_mul_f32 v99, v99, v18
    v_fma_f32 v96, v20, v92, v96
    v_fma_f32 v97, v21, v92, v97
    v_fma_f32 v98, v22, v92, v98
    v_fma_f32 v99, v23, v92, v99
    v_cvt_pk_bf16_f32 v20, v96, v97
    v_cvt_pk_bf16_f32 v21, v98, v99
    buffer_store_dwordx2 v[20:21], v93, s[72:75], 0 offen offset:0
    v_pk_add_f32 v[24:25], v[24:25], v[40:41]
    v_pk_add_f32 v[26:27], v[26:27], v[42:43]
    v_pk_add_f32 v[24:25], v[24:25], v[56:57]
    v_pk_add_f32 v[26:27], v[26:27], v[58:59]
    v_pk_add_f32 v[24:25], v[24:25], v[72:73]
    v_pk_add_f32 v[26:27], v[26:27], v[74:75]
    v_lshlrev_b32 v100, 16, v194
    v_and_b32 v101, s92, v194
    v_lshlrev_b32 v102, 16, v195
    v_and_b32 v103, s92, v195
    v_lshlrev_b32 v96, 16, v86
    v_and_b32 v97, s92, v86
    v_lshlrev_b32 v98, 16, v87
    v_and_b32 v99, s92, v87
    v_pk_add_f32 v[24:25], v[24:25], v[100:101]
    v_pk_add_f32 v[26:27], v[26:27], v[102:103]
    v_mul_f32 v96, v96, v18
    v_mul_f32 v97, v97, v18
    v_mul_f32 v98, v98, v18
    v_mul_f32 v99, v99, v18
    v_fma_f32 v96, v24, v92, v96
    v_fma_f32 v97, v25, v92, v97
    v_fma_f32 v98, v26, v92, v98
    v_fma_f32 v99, v27, v92, v99
    v_cvt_pk_bf16_f32 v24, v96, v97
    v_cvt_pk_bf16_f32 v25, v98, v99
    buffer_store_dwordx2 v[24:25], v93, s[72:75], 0 offen offset:32
    v_pk_add_f32 v[28:29], v[28:29], v[44:45]
    v_pk_add_f32 v[30:31], v[30:31], v[46:47]
    v_pk_add_f32 v[28:29], v[28:29], v[60:61]
    v_pk_add_f32 v[30:31], v[30:31], v[62:63]
    v_pk_add_f32 v[28:29], v[28:29], v[76:77]
    v_pk_add_f32 v[30:31], v[30:31], v[78:79]
    v_lshlrev_b32 v100, 16, v196
    v_and_b32 v101, s92, v196
    v_lshlrev_b32 v102, 16, v197
    v_and_b32 v103, s92, v197
    v_lshlrev_b32 v96, 16, v88
    v_and_b32 v97, s92, v88
    v_lshlrev_b32 v98, 16, v89
    v_and_b32 v99, s92, v89
    v_pk_add_f32 v[28:29], v[28:29], v[100:101]
    v_pk_add_f32 v[30:31], v[30:31], v[102:103]
    v_mul_f32 v96, v96, v18
    v_mul_f32 v97, v97, v18
    v_mul_f32 v98, v98, v18
    v_mul_f32 v99, v99, v18
    v_fma_f32 v96, v28, v92, v96
    v_fma_f32 v97, v29, v92, v97
    v_fma_f32 v98, v30, v92, v98
    v_fma_f32 v99, v31, v92, v99
    v_cvt_pk_bf16_f32 v28, v96, v97
    v_cvt_pk_bf16_f32 v29, v98, v99
    buffer_store_dwordx2 v[28:29], v93, s[72:75], 0 offen offset:64
    v_pk_add_f32 v[32:33], v[32:33], v[48:49]
    v_pk_add_f32 v[34:35], v[34:35], v[50:51]
    v_pk_add_f32 v[32:33], v[32:33], v[64:65]
    v_pk_add_f32 v[34:35], v[34:35], v[66:67]
    v_pk_add_f32 v[32:33], v[32:33], v[80:81]
    v_pk_add_f32 v[34:35], v[34:35], v[82:83]
    v_lshlrev_b32 v100, 16, v198
    v_and_b32 v101, s92, v198
    v_lshlrev_b32 v102, 16, v199
    v_and_b32 v103, s92, v199
    v_lshlrev_b32 v96, 16, v90
    v_and_b32 v97, s92, v90
    v_lshlrev_b32 v98, 16, v91
    v_and_b32 v99, s92, v91
    v_pk_add_f32 v[32:33], v[32:33], v[100:101]
    v_pk_add_f32 v[34:35], v[34:35], v[102:103]
    v_mul_f32 v96, v96, v18
    v_mul_f32 v97, v97, v18
    v_mul_f32 v98, v98, v18
    v_mul_f32 v99, v99, v18
    v_fma_f32 v96, v32, v92, v96
    v_fma_f32 v97, v33, v92, v97
    v_fma_f32 v98, v34, v92, v98
    v_fma_f32 v99, v35, v92, v99
    v_cvt_pk_bf16_f32 v32, v96, v97
    v_cvt_pk_bf16_f32 v33, v98, v99
    buffer_store_dwordx2 v[32:33], v93, s[72:75], 0 offen offset:96
    s_endpgm
roleB_2:
    s_setprio 1
    s_and_b32 s3, s84, 3
    s_lshl_b32 s94, s86, 7
    s_lshl_b32 s95, s3, 5
    s_add_u32 s94, s94, s95
    v_lshrrev_b32 v12, 3, v1
    v_add_u32 v12, s94, v12
    v_lshlrev_b32 v12, 10, v12
    v_and_b32 v13, 7, v1
    v_xor_b32 v13, v13, v11
    v_lshl_add_u32 v2, v13, 4, v12
    v_xor_b32 v13, 4, v13
    v_lshl_add_u32 v3, v13, 4, v12
    v_add_u32 v3, 7168, v3
    v_add_u32 v4, 14336, v2
    v_add_u32 v5, 14336, v3
    s_lshl_b32 s54, s3, 12
    s_lshr_b32 s92, s3, 1
    s_lshl_b32 s92, s92, 5
    s_and_b32 s93, s3, 1
    s_lshl_b32 s93, s93, 2
    s_add_u32 s92, s92, s93
    s_mul_i32 s92, s92, 3584
    s_mul_i32 s93, s87, 224
    s_add_u32 s92, s92, s93
    v_add_u32 v12, 0, v1
    v_mul_u32_u24 v13, 4682, v12
    v_lshrrev_b32 v13, 16, v13
    v_mul_u32_u24 v14, 14, v13
    v_sub_u32 v12, v12, v14
    v_lshlrev_b32 v12, 4, v12
    v_lshrrev_b32 v14, 2, v13
    v_lshlrev_b32 v14, 3, v14
    v_and_b32 v13, 3, v13
    v_add_u32 v13, v13, v14
    v_mul_u32_u24 v13, 3584, v13
    v_add3_u32 v6, v13, v12, s92
    v_add_u32 v12, 64, v1
    v_mul_u32_u24 v13, 4682, v12
    v_lshrrev_b32 v13, 16, v13
    v_mul_u32_u24 v14, 14, v13
    v_sub_u32 v12, v12, v14
    v_lshlrev_b32 v12, 4, v12
    v_lshrrev_b32 v14, 2, v13
    v_lshlrev_b32 v14, 3, v14
    v_and_b32 v13, 3, v13
    v_add_u32 v13, v13, v14
    v_mul_u32_u24 v13, 3584, v13
    v_add3_u32 v7, v13, v12, s92
    v_subrev_u32 v7, 1024, v7
    v_add_u32 v12, 128, v1
    v_mul_u32_u24 v13, 4682, v12
    v_lshrrev_b32 v13, 16, v13
    v_mul_u32_u24 v14, 14, v13
    v_sub_u32 v12, v12, v14
    v_lshlrev_b32 v12, 4, v12
    v_lshrrev_b32 v14, 2, v13
    v_lshlrev_b32 v14, 3, v14
    v_and_b32 v13, 3, v13
    v_add_u32 v13, v13, v14
    v_mul_u32_u24 v13, 3584, v13
    v_add3_u32 v8, v13, v12, s92
    v_subrev_u32 v8, 2048, v8
    v_add_u32 v12, 192, v1
    v_mul_u32_u24 v13, 4682, v12
    v_lshrrev_b32 v13, 16, v13
    v_mul_u32_u24 v14, 14, v13
    v_sub_u32 v12, v12, v14
    v_lshlrev_b32 v12, 4, v12
    v_lshrrev_b32 v14, 2, v13
    v_lshlrev_b32 v14, 3, v14
    v_and_b32 v13, 3, v13
    v_add_u32 v13, v13, v14
    v_mul_u32_u24 v13, 3584, v13
    v_add3_u32 v9, v13, v12, s92
    v_subrev_u32 v9, 3072, v9
    s_mul_i32 s55, s3, 3584
    s_lshr_b32 s93, s2, 3
    s_lshl_b32 s94, s93, 6
    s_lshl_b32 s95, s3, 4
    s_add_u32 s94, s94, s95
    v_lshrrev_b32 v16, 3, v1
    v_add_u32 v16, s94, v16
    v_lshlrev_b32 v16, 10, v16
    v_and_b32 v12, 7, v1
    v_lshl_add_u32 v16, v12, 4, v16
    s_and_b32 s92, s2, 7
    s_lshl_b32 s92, s92, 7
    v_add_u32 v16, s92, v16
    v_mov_b32 v12, 4096
    s_waitcnt lgkmcnt(0)
    s_and_b32 s0, s86, 1
    s_lshl_b32 s0, s0, 2
    s_add_u32 s0, s0, s87
    s_and_b32 s0, s0, 7
    s_and_b32 s1, s88, 1
    s_mov_b32 s40, s4
    s_mov_b32 s41, s5
    s_mov_b32 s42, 2097152
    s_mov_b32 s43, 0x20000
    buffer_load_dwordx4 v[20:23], v16, s[40:43], 0 offen
    s_mov_b32 s92, 8192
    buffer_load_dwordx4 v[24:27], v16, s[40:43], s92 offen
    s_add_u32 s48, s38, 12648448
    s_addc_u32 s49, s39, 0
    s_mov_b32 s50, 8192
    s_mov_b32 s51, 0x20000
    buffer_load_dword v17, v12, s[48:51], 0 offen sc1
    s_mov_b32 s44, s24
    s_mov_b32 s45, s25
    s_mov_b32 s46, 1835008
    s_mov_b32 s47, 0x20000
    s_add_u32 s52, s0, 0
    s_and_b32 s52, s52, 7
    s_add_u32 m0, s55, 32768
    s_mul_i32 s52, s52, 229376
    buffer_load_dwordx4 v6, s[44:47], s52 offen lds
    buffer_load_dwordx4 v7, s[44:47], s52 offen offset:1024 lds
    buffer_load_dwordx4 v8, s[44:47], s52 offen offset:2048 lds
    s_mov_b32 exec_hi, 0
    buffer_load_dwordx4 v9, s[44:47], s52 offen offset:3072 lds
    s_mov_b32 exec_hi, -1
    s_add_u32 s52, s0, 0
    s_and_b32 s52, s52, 7
    s_add_u32 m0, s54, 0
    s_lshl_b32 s52, s52, 7
    buffer_load_dwordx4 v2, s[40:43], s52 offen lds
    buffer_load_dwordx4 v3, s[40:43], s52 offen offset:1024 lds
    buffer_load_dwordx4 v4, s[40:43], s52 offen offset:2048 lds
    buffer_load_dwordx4 v5, s[40:43], s52 offen offset:3072 lds
    s_add_u32 s64, s38, 8388608
    s_addc_u32 s65, s39, 0
    s_mov_b32 s66, 2097152
    s_mov_b32 s67, 0x20000
    s_mov_b32 s60, s28
    s_mov_b32 s61, s29
    s_mov_b32 s62, 1835008
    s_mov_b32 s63, 0x20000
    s_mov_b32 s56, s38
    s_mov_b32 s57, s39
    s_mov_b32 s58, 7340032
    s_mov_b32 s59, 0x20000
    s_add_u32 s68, s38, 10485760
    s_addc_u32 s69, s39, 0
    s_mov_b32 s70, 2097152
    s_mov_b32 s71, 0x20000
    s_lshl_b32 s92, s3, 11
    s_add_u32 s92, s92, 150304
    v_lshlrev_b32 v12, 4, v1
    v_add_u32 v12, s92, v12
    v_bfe_u32 v13, v1, 2, 3
    v_lshlrev_b32 v13, 7, v13
    v_lshrrev_b32 v14, 5, v1
    v_lshl_add_u32 v13, v14, 6, v13
    v_and_b32 v14, 3, v1
    v_lshl_add_u32 v13, v14, 3, v13
    v_add_u32 v13, s92, v13
    s_and_b32 s92, s2, 7
    s_lshl_b32 s92, s92, 18
    s_and_b32 s93, s85, 31
    s_lshl_b32 s93, s93, 7
    s_add_u32 s92, s92, s93
    s_lshl_b32 s93, s3, 5
    s_add_u32 s92, s92, s93
    v_lshrrev_b32 v14, 5, v1
    v_lshl_add_u32 v14, v14, 5, v10
    v_lshlrev_b32 v14, 12, v14
    v_bfe_u32 v15, v1, 4, 1
    v_lshl_add_u32 v14, v15, 3, v14
    v_add_u32 v14, s92, v14
    s_waitcnt vmcnt(8)
    v_readfirstlane_b32 s90, v17
    s_nop 3
    s_mul_i32 s90, s90, 0x9E3779B1
    s_add_u32 s90, s90, 0x7F4A7C15
    s_cmp_lg_u32 s3, 0
    s_cbranch_scc1 recw_27
    s_getreg_b32 s92, hwreg(HW_REG_XCC_ID, 0, 4)
    s_add_u32 s92, s92, s90
    s_lshl_b32 s93, s85, 2
    s_add_u32 s93, s93, 3072
    v_mov_b32 v16, s92
    v_mov_b32 v17, s93
    s_mov_b64 exec, 1
    buffer_store_dword v16, v17, s[48:51], 0 offen sc1
    s_mov_b64 exec, -1
recw_27:
    ds_write_b128 v12, v[20:23]
    ds_write_b128 v12, v[24:27] offset:1024
    s_waitcnt lgkmcnt(0)
    ds_read_b64_tr_b16 v[28:29], v13 offset:0
    ds_read_b64_tr_b16 v[30:31], v13 offset:32
    ds_read_b64_tr_b16 v[32:33], v13 offset:1024
    ds_read_b64_tr_b16 v[34:35], v13 offset:1056
    s_mov_b32 s93, 65536
    s_waitcnt lgkmcnt(0)
    buffer_store_dwordx2 v[28:29], v14, s[64:67], 0 offen offset:0
    buffer_store_dwordx2 v[30:31], v14, s[64:67], s93 offen offset:0
    buffer_store_dwordx2 v[32:33], v14, s[64:67], 0 offen offset:16
    buffer_store_dwordx2 v[34:35], v14, s[64:67], s93 offen offset:16
    s_add_u32 s52, s0, 1
    s_and_b32 s52, s52, 7
    s_add_u32 m0, s55, 47104
    s_mul_i32 s52, s52, 229376
    buffer_load_dwordx4 v6, s[44:47], s52 offen lds
    buffer_load_dwordx4 v7, s[44:47], s52 offen offset:1024 lds
    buffer_load_dwordx4 v8, s[44:47], s52 offen offset:2048 lds
    s_mov_b32 exec_hi, 0
    buffer_load_dwordx4 v9, s[44:47], s52 offen offset:3072 lds
    s_mov_b32 exec_hi, -1
    s_add_u32 s52, s0, 1
    s_and_b32 s52, s52, 7
    s_add_u32 m0, s54, 16384
    s_lshl_b32 s52, s52, 7
    buffer_load_dwordx4 v2, s[40:43], s52 offen lds
    buffer_load_dwordx4 v3, s[40:43], s52 offen offset:1024 lds
    buffer_load_dwordx4 v4, s[40:43], s52 offen offset:2048 lds
    buffer_load_dwordx4 v5, s[40:43], s52 offen offset:3072 lds
    s_add_u32 s52, s0, 2
    s_and_b32 s52, s52, 7
    s_add_u32 m0, s55, 61440
    s_mul_i32 s52, s52, 229376
    buffer_load_dwordx4 v6, s[44:47], s52 offen lds
    buffer_load_dwordx4 v7, s[44:47], s52 offen offset:1024 lds
    buffer_load_dwordx4 v8, s[44:47], s52 offen offset:2048 lds
    s_mov_b32 exec_hi, 0
    buffer_load_dwordx4 v9, s[44:47], s52 offen offset:3072 lds
    s_mov_b32 exec_hi, -1
    s_add_u32 s52, s0, 3
    s_and_b32 s52, s52, 7
    s_add_u32 m0, s55, 75776
    s_mul_i32 s52, s52, 229376
    buffer_load_dwordx4 v6, s[44:47], s52 offen lds
    buffer_load_dwordx4 v7, s[44:47], s52 offen offset:1024 lds
    buffer_load_dwordx4 v8, s[44:47], s52 offen offset:2048 lds
    s_mov_b32 exec_hi, 0
    buffer_load_dwordx4 v9, s[44:47], s52 offen offset:3072 lds
    s_mov_b32 exec_hi, -1
    s_and_b32 s92, s2, 7
    s_lshl_b32 s92, s92, 5
    v_and_b32 v18, 31, v1
    v_add_u32 v18, s92, v18
    v_lshlrev_b32 v18, 2, v18
    v_add_u32 v18, 3072, v18
    s_waitcnt vmcnt(20)
    s_barrier
    s_add_u32 s52, s0, 2
    s_and_b32 s52, s52, 7
    s_add_u32 m0, s54, 90112
    s_lshl_b32 s52, s52, 7
    buffer_load_dwordx4 v2, s[40:43], s52 offen lds
    buffer_load_dwordx4 v3, s[40:43], s52 offen offset:1024 lds
    buffer_load_dwordx4 v4, s[40:43], s52 offen offset:2048 lds
    buffer_load_dwordx4 v5, s[40:43], s52 offen offset:3072 lds
    s_add_u32 s52, s0, 4
    s_and_b32 s52, s52, 7
    s_add_u32 m0, s55, 106496
    s_mul_i32 s52, s52, 229376
    buffer_load_dwordx4 v6, s[44:47], s52 offen lds
    buffer_load_dwordx4 v7, s[44:47], s52 offen offset:1024 lds
    buffer_load_dwordx4 v8, s[44:47], s52 offen offset:2048 lds
    s_mov_b32 exec_hi, 0
    buffer_load_dwordx4 v9, s[44:47], s52 offen offset:3072 lds
    s_mov_b32 exec_hi, -1
    buffer_load_dword v19, v18, s[48:51], 0 offen sc1
    s_waitcnt vmcnt(17)
    s_barrier
    s_add_u32 s52, s0, 3
    s_and_b32 s52, s52, 7
    s_add_u32 m0, s54, 0
    s_lshl_b32 s52, s52, 7
    buffer_load_dwordx4 v2, s[40:43], s52 offen lds
    buffer_load_dwordx4 v3, s[40:43], s52 offen offset:1024 lds
    buffer_load_dwordx4 v4, s[40:43], s52 offen offset:2048 lds
    buffer_load_dwordx4 v5, s[40:43], s52 offen offset:3072 lds
    s_add_u32 s52, s0, 5
    s_and_b32 s52, s52, 7
    s_add_u32 m0, s55, 32768
    s_mul_i32 s52, s52, 229376
    buffer_load_dwordx4 v6, s[44:47], s52 offen lds
    buffer_load_dwordx4 v7, s[44:47], s52 offen offset:1024 lds
    buffer_load_dwordx4 v8, s[44:47], s52 offen offset:2048 lds
    s_mov_b32 exec_hi, 0
    buffer_load_dwordx4 v9, s[44:47], s52 offen offset:3072 lds
    s_mov_b32 exec_hi, -1
    s_waitcnt vmcnt(8)
    s_mov_b32 s53, 100000
rchk_28:
    v_subrev_u32 v19, s90, v19
    v_cmp_le_u32 vcc, 16, v19
    s_cmp_eq_u64 vcc, 0
    s_cbranch_scc1 rchkd_29
    s_sleep 1
    buffer_load_dword v19, v18, s[48:51], 0 offen sc1
    s_waitcnt vmcnt(0)
    s_sub_u32 s53, s53, 1
    s_cmp_lg_u32 s53, 0
    s_cbranch_scc1 rchk_28
    v_subrev_u32 v19, s90, v19
rchkd_29:
    s_getreg_b32 s92, hwreg(HW_REG_XCC_ID, 0, 4)
    s_nop 0
    v_cmp_ne_u32 vcc, s92, v19
    s_cmp_eq_u64 vcc, 0
    s_cselect_b32 s91, 1, 0
    s_cmp_lg_u32 s91, 0
    s_cbranch_scc1 rel_30
    buffer_wbl2 sc1
    s_waitcnt vmcnt(0)
rel_30:
    s_barrier
    s_add_u32 s52, s0, 4
    s_and_b32 s52, s52, 7
    s_add_u32 m0, s54, 16384
    s_lshl_b32 s52, s52, 7
    buffer_load_dwordx4 v2, s[40:43], s52 offen lds
    buffer_load_dwordx4 v3, s[40:43], s52 offen offset:1024 lds
    buffer_load_dwordx4 v4, s[40:43], s52 offen offset:2048 lds
    buffer_load_dwordx4 v5, s[40:43], s52 offen offset:3072 lds
    s_add_u32 s52, s0, 6
    s_and_b32 s52, s52, 7
    s_add_u32 m0, s55, 47104
    s_mul_i32 s52, s52, 229376
    buffer_load_dwordx4 v6, s[44:47], s52 offen lds
    buffer_load_dwordx4 v7, s[44:47], s52 offen offset:1024 lds
    buffer_load_dwordx4 v8, s[44:47], s52 offen offset:2048 lds
    s_mov_b32 exec_hi, 0
    buffer_load_dwordx4 v9, s[44:47], s52 offen offset:3072 lds
    s_mov_b32 exec_hi, -1
    s_cmp_lg_u32 s3, 0
    s_cbranch_scc1 fup_31
    s_lshl_b32 s92, s85, 2
    s_add_u32 s92, s92, 1024
    s_cmp_eq_u32 s91, 0
    s_cbranch_scc1 fups_32
    v_mov_b32 v12, s90
    v_mov_b32 v13, s92
    s_mov_b64 exec, 1
    buffer_store_dword v12, v13, s[48:51], 0 offen
    s_mov_b64 exec, -1
    s_branch fup_31
fups_32:
    v_mov_b32 v12, s90
    v_mov_b32 v13, s92
    s_mov_b64 exec, 1
    buffer_store_dword v12, v13, s[48:51], 0 offen sc1
    s_mov_b64 exec, -1
fup_31:
    s_waitcnt vmcnt(12)
    s_barrier
    s_add_u32 s52, s0, 5
    s_and_b32 s52, s52, 7
    s_add_u32 m0, s54, 90112
    s_lshl_b32 s52, s52, 7
    buffer_load_dwordx4 v2, s[40:43], s52 offen lds
    buffer_load_dwordx4 v3, s[40:43], s52 offen offset:1024 lds
    buffer_load_dwordx4 v4, s[40:43], s52 offen offset:2048 lds
    buffer_load_dwordx4 v5, s[40:43], s52 offen offset:3072 lds
    s_add_u32 s52, s0, 7
    s_and_b32 s52, s52, 7
    s_add_u32 m0, s55, 61440
    s_mul_i32 s52, s52, 229376
    buffer_load_dwordx4 v6, s[44:47], s52 offen lds
    buffer_load_dwordx4 v7, s[44:47], s52 offen offset:1024 lds
    buffer_load_dwordx4 v8, s[44:47], s52 offen offset:2048 lds
    s_mov_b32 exec_hi, 0
    buffer_load_dwordx4 v9, s[44:47], s52 offen offset:3072 lds
    s_mov_b32 exec_hi, -1
    s_waitcnt vmcnt(12)
    s_barrier
    s_add_u32 s52, s0, 6
    s_and_b32 s52, s52, 7
    s_add_u32 m0, s54, 0
    s_lshl_b32 s52, s52, 7
    buffer_load_dwordx4 v2, s[40:43], s52 offen lds
    buffer_load_dwordx4 v3, s[40:43], s52 offen offset:1024 lds
    buffer_load_dwordx4 v4, s[40:43], s52 offen offset:2048 lds
    buffer_load_dwordx4 v5, s[40:43], s52 offen offset:3072 lds
    s_and_b32 s92, s2, 7
    s_lshl_b32 s92, s92, 7
    s_add_u32 s92, s92, 1024
    v_and_b32 v50, 31, v1
    v_lshlrev_b32 v50, 2, v50
    v_add_u32 v50, s92, v50
    buffer_load_dword v51, v50, s[48:51], 0 offen sc1
    s_waitcnt vmcnt(9)
    s_barrier
    s_add_u32 s52, s0, 7
    s_and_b32 s52, s52, 7
    s_add_u32 m0, s54, 16384
    s_lshl_b32 s52, s52, 7
    buffer_load_dwordx4 v2, s[40:43], s52 offen lds
    buffer_load_dwordx4 v3, s[40:43], s52 offen offset:1024 lds
    buffer_load_dwordx4 v4, s[40:43], s52 offen offset:2048 lds
    buffer_load_dwordx4 v5, s[40:43], s52 offen offset:3072 lds
    s_waitcnt vmcnt(5)
    s_barrier
    s_waitcnt vmcnt(4)
    s_mov_b32 s53, 100000
    s_branch pollc_35
poll_33:
    buffer_load_dword v51, v50, s[48:51], 0 offen sc1
    s_waitcnt vmcnt(0)
pollc_35:
    v_cmp_ne_u32 vcc, s90, v51
    s_cmp_eq_u64 vcc, 0
    s_cbranch_scc1 polld_34
    s_sleep 1
    s_sub_u32 s53, s53, 1
    s_cmp_lg_u32 s53, 0
    s_cbranch_scc1 poll_33
polld_34:
    s_cmp_lg_u32 s91, 0
    s_cbranch_scc1 acq_36
    buffer_inv sc1
    s_waitcnt vmcnt(0)
acq_36:
    s_lshl_b32 s92, s85, 1
    s_lshr_b32 s93, s3, 1
    s_add_u32 s92, s92, s93
    s_lshl_b32 s92, s92, 12
    s_and_b32 s94, s3, 1
    s_lshl_b32 s94, s94, 11
    s_add_u32 s92, s92, s94
    v_lshlrev_b32 v12, 4, v1
    v_add_u32 v12, s92, v12
    s_mul_i32 s93, s93, 4608
    s_add_u32 s93, s93, 150304
    s_add_u32 s95, s93, s94
    s_add_u32 m0, s95, 512
    s_nop 0
    buffer_load_dwordx4 v12, s[64:67], 0 offen lds
    buffer_load_dwordx4 v12, s[64:67], 0 offen offset:1024 lds
    v_mov_b32 v14, 0
    v_mov_b32 v15, 0
    v_lshlrev_b32 v13, 3, v1
    v_add_u32 v13, s93, v13
    ds_write_b64 v13, v[14:15]
    s_waitcnt vmcnt(2)
    s_barrier
    s_barrier
    v_lshrrev_b32 v12, 3, v1
    v_lshlrev_b32 v12, 10, v12
    v_bfe_u32 v13, v1, 4, 2
    v_lshlrev_b32 v13, 1, v13
    v_and_b32 v14, 7, v1
    v_xor_b32 v13, v13, v14
    v_lshl_add_u32 v12, v13, 4, v12
    s_lshl_b32 s92, s89, 7
    v_add_u32 v2, s92, v12
    v_add_u32 v3, 7168, v2
    v_add_u32 v4, 14336, v2
    v_add_u32 v5, 21504, v2
    s_mul_i32 s54, s3, 458752
    s_mul_i32 s93, s1, 229376
    s_add_u32 s0, s54, 229376
    s_sub_u32 s0, s0, s93
    s_add_u32 s54, s54, s93
    s_lshl_b32 s55, s3, 12
    s_waitcnt vmcnt(0)
    s_waitcnt lgkmcnt(0)
    s_barrier
    s_cmp_lg_u32 s3, 0
    s_cbranch_scc1 pb_37
    s_lshl_b32 s92, s85, 2
    s_add_u32 s92, s92, 0
    s_cmp_eq_u32 s91, 0
    s_cbranch_scc1 pbs_38
    v_mov_b32 v14, s90
    v_mov_b32 v15, s92
    s_mov_b64 exec, 1
    buffer_store_dword v14, v15, s[48:51], 0 offen
    s_mov_b64 exec, -1
    s_branch pb_37
pbs_38:
    v_mov_b32 v14, s90
    v_mov_b32 v15, s92
    s_mov_b64 exec, 1
    buffer_store_dword v14, v15, s[48:51], 0 offen sc1
    s_mov_b64 exec, -1
pb_37:
    s_add_u32 m0, s55, 0
    s_add_u32 s52, s54, 0
    buffer_load_dwordx4 v2, s[60:63], s52 offen lds
    buffer_load_dwordx4 v3, s[60:63], s52 offen offset:1024 lds
    buffer_load_dwordx4 v4, s[60:63], s52 offen offset:2048 lds
    buffer_load_dwordx4 v5, s[60:63], s52 offen offset:3072 lds
    s_add_u32 m0, s55, 16384
    s_add_u32 s52, s54, 32768
    buffer_load_dwordx4 v2, s[60:63], s52 offen lds
    buffer_load_dwordx4 v3, s[60:63], s52 offen offset:1024 lds
    buffer_load_dwordx4 v4, s[60:63], s52 offen offset:2048 lds
    buffer_load_dwordx4 v5, s[60:63], s52 offen offset:3072 lds
    s_add_u32 m0, s55, 32768
    s_add_u32 s52, s54, 65536
    buffer_load_dwordx4 v2, s[60:63], s52 offen lds
    buffer_load_dwordx4 v3, s[60:63], s52 offen offset:1024 lds
    buffer_load_dwordx4 v4, s[60:63], s52 offen offset:2048 lds
    buffer_load_dwordx4 v5, s[60:63], s52 offen offset:3072 lds
    s_add_u32 m0, s55, 49152
    s_add_u32 s52, s54, 114688
    buffer_load_dwordx4 v2, s[60:63], s52 offen lds
    buffer_load_dwordx4 v3, s[60:63], s52 offen offset:1024 lds
    buffer_load_dwordx4 v4, s[60:63], s52 offen offset:2048 lds
    buffer_load_dwordx4 v5, s[60:63], s52 offen offset:3072 lds
    s_add_u32 m0, s55, 65536
    s_add_u32 s52, s54, 147456
    buffer_load_dwordx4 v2, s[60:63], s52 offen lds
    buffer_load_dwordx4 v3, s[60:63], s52 offen offset:1024 lds
    buffer_load_dwordx4 v4, s[60:63], s52 offen offset:2048 lds
    buffer_load_dwordx4 v5, s[60:63], s52 offen offset:3072 lds
    s_add_u32 m0, s55, 81920
    s_add_u32 s52, s54, 180224
    buffer_load_dwordx4 v2, s[60:63], s52 offen lds
    buffer_load_dwordx4 v3, s[60:63], s52 offen offset:1024 lds
    buffer_load_dwordx4 v4, s[60:63], s52 offen offset:2048 lds
    buffer_load_dwordx4 v5, s[60:63], s52 offen offset:3072 lds
    s_waitcnt vmcnt(20)
    s_barrier
    s_cmp_lg_u32 s3, 0
    s_cbranch_scc1 pfa_39
    s_lshl_b32 s92, s85, 2
    s_add_u32 s92, s92, 2048
    v_mov_b32 v246, s90
    v_mov_b32 v247, s92
    s_mov_b64 exec, 1
    buffer_store_dword v246, v247, s[48:51], 0 offen sc1
    s_mov_b64 exec, -1
pfa_39:
    s_add_u32 m0, s55, 131072
    s_add_u32 s52, s54, 98304
    buffer_load_dwordx4 v2, s[60:63], s52 offen lds
    buffer_load_dwordx4 v3, s[60:63], s52 offen offset:1024 lds
    s_add_u32 s52, s54, 196608
    buffer_load_dwordx4 v4, s[60:63], s52 offen offset:2048 lds
    buffer_load_dwordx4 v5, s[60:63], s52 offen offset:3072 lds
    s_waitcnt vmcnt(20)
    s_waitcnt lgkmcnt(0)
    s_barrier
    s_add_u32 m0, s55, 0
    s_add_u32 s52, s0, 0
    buffer_load_dwordx4 v2, s[60:63], s52 offen lds
    buffer_load_dwordx4 v3, s[60:63], s52 offen offset:1024 lds
    buffer_load_dwordx4 v4, s[60:63], s52 offen offset:2048 lds
    buffer_load_dwordx4 v5, s[60:63], s52 offen offset:3072 lds
    s_waitcnt vmcnt(20)
    s_waitcnt lgkmcnt(0)
    s_barrier
    s_add_u32 m0, s55, 16384
    s_add_u32 s52, s0, 32768
    buffer_load_dwordx4 v2, s[60:63], s52 offen lds
    buffer_load_dwordx4 v3, s[60:63], s52 offen offset:1024 lds
    buffer_load_dwordx4 v4, s[60:63], s52 offen offset:2048 lds
    buffer_load_dwordx4 v5, s[60:63], s52 offen offset:3072 lds
    s_waitcnt vmcnt(20)
    s_waitcnt lgkmcnt(0)
    s_barrier
    s_add_u32 m0, s55, 32768
    s_add_u32 s52, s0, 65536
    buffer_load_dwordx4 v2, s[60:63], s52 offen lds
    buffer_load_dwordx4 v3, s[60:63], s52 offen offset:1024 lds
    buffer_load_dwordx4 v4, s[60:63], s52 offen offset:2048 lds
    buffer_load_dwordx4 v5, s[60:63], s52 offen offset:3072 lds
    s_lshl_b32 s92, s89, 5
    v_and_b32 v244, 31, v1
    v_add_u32 v244, s92, v244
    s_lshl_b32 s92, s88, 3
    v_and_b32 v245, 7, v1
    v_add_u32 v245, s92, v245
    v_cmp_gt_u32 vcc, 32, v1
    s_nop 1
    v_cndmask_b32 v244, v245, v244, vcc
    v_lshlrev_b32 v244, 2, v244
    v_add_u32 v244, 2048, v244
    buffer_load_dword v245, v244, s[48:51], 0 offen sc1
    s_waitcnt vmcnt(21)
    s_waitcnt lgkmcnt(0)
    s_barrier
    s_add_u32 m0, s55, 49152
    s_add_u32 s52, s0, 114688
    buffer_load_dwordx4 v2, s[60:63], s52 offen lds
    buffer_load_dwordx4 v3, s[60:63], s52 offen offset:1024 lds
    buffer_load_dwordx4 v4, s[60:63], s52 offen offset:2048 lds
    buffer_load_dwordx4 v5, s[60:63], s52 offen offset:3072 lds
    s_waitcnt vmcnt(21)
    s_waitcnt lgkmcnt(0)
    s_barrier
    s_add_u32 m0, s55, 65536
    s_add_u32 s52, s0, 147456
    buffer_load_dwordx4 v2, s[60:63], s52 offen lds
    buffer_load_dwordx4 v3, s[60:63], s52 offen offset:1024 lds
    buffer_load_dwordx4 v4, s[60:63], s52 offen offset:2048 lds
    buffer_load_dwordx4 v5, s[60:63], s52 offen offset:3072 lds
    s_waitcnt vmcnt(21)
    s_waitcnt lgkmcnt(0)
    s_barrier
    s_add_u32 m0, s55, 81920
    s_add_u32 s52, s0, 180224
    buffer_load_dwordx4 v2, s[60:63], s52 offen lds
    buffer_load_dwordx4 v3, s[60:63], s52 offen offset:1024 lds
    buffer_load_dwordx4 v4, s[60:63], s52 offen offset:2048 lds
    buffer_load_dwordx4 v5, s[60:63], s52 offen offset:3072 lds
    s_waitcnt vmcnt(12)
    s_mov_b32 s53, 100000
    s_branch pollc_42
poll_40:
    buffer_load_dword v245, v244, s[48:51], 0 offen sc1
    s_waitcnt vmcnt(0)
pollc_42:
    v_cmp_ne_u32 vcc, s90, v245
    s_cmp_eq_u64 vcc, 0
    s_cbranch_scc1 polld_41
    s_sleep 1
    s_sub_u32 s53, s53, 1
    s_cmp_lg_u32 s53, 0
    s_cbranch_scc1 poll_40
polld_41:
    v_lshrrev_b32 v244, 3, v1
    s_lshl_b32 s92, s89, 6
    s_lshl_b32 s93, s3, 4
    s_add_u32 s92, s92, s93
    v_add_u32 v244, s92, v244
    v_lshlrev_b32 v244, 12, v244
    v_and_b32 v245, 7, v1
    v_lshl_add_u32 v244, v245, 4, v244
    s_lshl_b32 s92, s88, 7
    v_add_u32 v244, s92, v244
    s_mov_b32 s93, 32768
    buffer_load_dwordx4 v[20:23], v244, s[68:71], 0 offen sc1
    buffer_load_dwordx4 v[24:27], v244, s[68:71], s93 offen sc1
    s_waitcnt lgkmcnt(0)
    s_barrier
    s_add_u32 m0, s55, 131072
    s_add_u32 s52, s0, 98304
    buffer_load_dwordx4 v2, s[60:63], s52 offen lds
    buffer_load_dwordx4 v3, s[60:63], s52 offen offset:1024 lds
    s_add_u32 s52, s0, 196608
    buffer_load_dwordx4 v4, s[60:63], s52 offen offset:2048 lds
    buffer_load_dwordx4 v5, s[60:63], s52 offen offset:3072 lds
    s_waitcnt lgkmcnt(0)
    s_barrier
    s_waitcnt lgkmcnt(0)
    s_barrier
    s_waitcnt vmcnt(14)
    s_waitcnt lgkmcnt(0)
    s_barrier
    s_waitcnt vmcnt(10)
    s_waitcnt lgkmcnt(0)
    s_barrier
    s_waitcnt vmcnt(6)
    s_waitcnt lgkmcnt(0)
    s_barrier
    s_waitcnt vmcnt(0)
    s_waitcnt lgkmcnt(0)
    s_barrier
    s_lshl_b32 s92, s3, 11
    s_add_u32 s92, s92, 147456
    v_lshlrev_b32 v28, 4, v1
    v_add_u32 v28, s92, v28
    ds_write_b128 v28, v[20:23]
    ds_write_b128 v28, v[24:27] offset:1024
    s_waitcnt lgkmcnt(0)
    s_barrier
    s_or_b32 s92, s85, s3
    s_cmp_lg_u32 s92, 0
    s_cbranch_scc1 fin_43
    v_lshlrev_b32 v12, 2, v1
    v_add_u32 v12, 2048, v12
    s_mov_b32 s53, 100000
poll_44:
    buffer_load_dword v13, v12, s[48:51], 0 offen sc1
    s_waitcnt vmcnt(0)
pollc_46:
    v_cmp_ne_u32 vcc, s90, v13
    s_cmp_eq_u64 vcc, 0
    s_cbranch_scc1 polld_45
    s_sleep 1
    s_sub_u32 s53, s53, 1
    s_cmp_lg_u32 s53, 0
    s_cbranch_scc1 poll_44
polld_45:
    v_lshlrev_b32 v12, 2, v1
    v_add_u32 v12, 2304, v12
    s_mov_b32 s53, 100000
poll_47:
    buffer_load_dword v13, v12, s[48:51], 0 offen sc1
    s_waitcnt vmcnt(0)
pollc_49:
    v_cmp_ne_u32 vcc, s90, v13
    s_cmp_eq_u64 vcc, 0
    s_cbranch_scc1 polld_48
    s_sleep 1
    s_sub_u32 s53, s53, 1
    s_cmp_lg_u32 s53, 0
    s_cbranch_scc1 poll_47
polld_48:
    v_lshlrev_b32 v12, 2, v1
    v_add_u32 v12, 2560, v12
    s_mov_b32 s53, 100000
poll_50:
    buffer_load_dword v13, v12, s[48:51], 0 offen sc1
    s_waitcnt vmcnt(0)
pollc_52:
    v_cmp_ne_u32 vcc, s90, v13
    s_cmp_eq_u64 vcc, 0
    s_cbranch_scc1 polld_51
    s_sleep 1
    s_sub_u32 s53, s53, 1
    s_cmp_lg_u32 s53, 0
    s_cbranch_scc1 poll_50
polld_51:
    v_lshlrev_b32 v12, 2, v1
    v_add_u32 v12, 2816, v12
    s_mov_b32 s53, 100000
poll_53:
    buffer_load_dword v13, v12, s[48:51], 0 offen sc1
    s_waitcnt vmcnt(0)
pollc_55:
    v_cmp_ne_u32 vcc, s90, v13
    s_cmp_eq_u64 vcc, 0
    s_cbranch_scc1 polld_54
    s_sleep 1
    s_sub_u32 s53, s53, 1
    s_cmp_lg_u32 s53, 0
    s_cbranch_scc1 poll_53
polld_54:
    s_mov_b32 s92, 4096
    v_mov_b32 v12, s90
    v_mov_b32 v13, s92
    s_mov_b64 exec, 1
    buffer_store_dword v12, v13, s[48:51], 0 offen sc1
    s_mov_b64 exec, -1
fin_43:
    s_endpgm
k_end_1:
    s_endpgm
.section .rodata,"a"
.p2align 6
.amdhsa_kernel gated_mix__ssm_conv_s4__dense_activation_squared_relu__prompt_kernel
  .amdhsa_next_free_vgpr 256
  .amdhsa_next_free_sgpr 96
  .amdhsa_accum_offset 256
  .amdhsa_group_segment_fixed_size 0
  .amdhsa_kernarg_size 144
  .amdhsa_user_sgpr_count 2
  .amdhsa_user_sgpr_kernarg_segment_ptr 1
  .amdhsa_system_sgpr_workgroup_id_x 1
.end_amdhsa_kernel
```
